```python
import torch

def _softmax(x, axis=-1):
    return torch.softmax(x, dim=axis)
def _gelu(x):
    return torch.nn.functional.gelu(x, approximate="tanh")
def _silu(x):
    return torch.nn.functional.silu(x)
def _sigmoid(x):
    return torch.sigmoid(x)
def _layernorm(x, axis=-1, eps=1e-5):
    m = x.mean(dim=axis, keepdim=True)
    v = x.var(dim=axis, keepdim=True, unbiased=False)
    return (x - m) / torch.sqrt(v + eps)
def _scatter_add(tgt, idx, src, axis=0):
    return tgt.clone().index_add_(axis, idx, src)
def _segment_sum(src, seg, n):
    out = torch.zeros((n,) + src.shape[1:], dtype=src.dtype)
    return out.index_add_(0, seg, src)
def _pad(x, pw):
    flat = tuple(v for pair in reversed(pw) for v in pair)
    return torch.nn.functional.pad(x, flat)

kernel_name = 'standalone__low_rank_proj_linformer__sampling'

def setup_inputs():

    _w = (lambda a: (lambda t: t.to(torch.bfloat16) if t.is_floating_point() else t)(torch.as_tensor(a)))
    B, H, Sq, Skv, Dh, R = 16, 32, 1, 2048, 128, 64
    return {
        "q": _w((lambda *s: torch.randn(*s, dtype=torch.bfloat16) * 0.8)(B, H, Sq, Dh)),
        "k": _w((lambda *s: torch.randn(*s, dtype=torch.bfloat16) * 0.8)(B, H, Skv, Dh)),
        "v": _w((lambda *s: torch.randn(*s, dtype=torch.bfloat16) * 0.05)(B, H, Skv, Dh)),
        "e_proj": _w((lambda *s: torch.randn(*s, dtype=torch.bfloat16) * 0.8)(R, Skv) * (Skv ** -0.5)),
        "f_proj": _w((lambda *s: torch.randn(*s, dtype=torch.bfloat16) * 0.05)(R, Skv) * (Skv ** -0.5)),
    }

def reference(q, k, v, e_proj, f_proj):
    B, H, Sq, Dh = q.shape
    kp = torch.einsum("rn,bhnd->bhrd", e_proj, k)
    vp = torch.einsum("rn,bhnd->bhrd", f_proj, v)
    scores = torch.einsum("bhqd,bhrd->bhqr", q, kp) * (Dh ** -0.5)
    p = _softmax(scores, axis=-1)
    o = torch.einsum("bhqr,bhrd->bhqd", p, vp)
    return o
```

```asm
; @launch grid=(256,1,1) block=(512,1,1) lds=20480
.amdgcn_target "amdgcn-amd-amdhsa--gfx950"
.text
.globl standalone__low_rank_proj_linformer__sampling_kernel
.p2align 8
.type standalone__low_rank_proj_linformer__sampling_kernel,@function
standalone__low_rank_proj_linformer__sampling_kernel:
    s_cmp_ge_u32 s2, 256
    s_cbranch_scc1 L_end
    s_load_dwordx8 s[4:11], s[0:1], 0
    s_load_dwordx4 s[12:15], s[0:1], 32
    s_load_dwordx2 s[76:77], s[0:1], 56
    v_lshrrev_b32 v5, 6, v0
    v_and_b32 v0, 63, v0
    v_readfirstlane_b32 s3, v5
    v_and_b32 v5, 15, v0
    v_lshrrev_b32 v6, 4, v0
    v_lshlrev_b32 v7, 4, v5
    v_lshl_add_u32 v1, v6, 11, v7
    s_lshr_b32 s39, s2, 5
    s_and_b32 s39, s39, 7
    s_xor_b32 s39, s39, s2
    s_lshl_b32 s32, s39, 20
    s_mov_b32 s74, 256
    s_lshl_b32 s38, s3, 14
    s_add_u32 s32, s32, s38
    s_lshl_b32 s46, s3, 7
    s_lshr_b32 s36, s3, 2
    s_and_b32 s36, s36, 1
    s_lshl_b32 s38, s36, 13
    s_add_u32 s32, s32, s38
    s_lshr_b32 s86, s3, 0
    s_mul_i32 s86, s86, 2
    s_and_b32 s86, s86, 3
    s_lshl_b32 s38, s86, 17
    s_add_u32 s32, s32, s38
    s_lshl_b32 s86, s86, 10
    s_add_u32 s85, s46, s86
    s_xor_b32 s33, s32, 0x2000
    s_mov_b32 s18, 0x10000000
    s_mov_b32 s19, 0x00020000
    s_mov_b32 s30, 0x20000
    s_mov_b32 s31, 0x00020000
    s_lshl_b32 s47, s39, 9
    s_add_u32 s37, s47, s74
    s_xor_b32 s34, s32, 0
    s_add_u32 s35, s34, 0x80000
    s_waitcnt lgkmcnt(0)
    s_mov_b32 s16, s6
    s_mov_b32 s17, s7
    s_mov_b32 s28, s4
    s_mov_b32 s29, s5
    buffer_load_dwordx4 v[64:67], v1, s[16:19], s34 offen offset:0 nt
    buffer_load_dwordx4 v[12:15], v7, s[28:31], s47 offen
    buffer_load_dwordx4 v[16:19], v7, s[28:31], s37 offen
    buffer_load_dwordx4 v[68:71], v1, s[16:19], s34 offen offset:256 nt
    buffer_load_dwordx4 v[72:75], v1, s[16:19], s34 offen offset:512 nt
    s_mov_b32 s48, s8
    s_mov_b32 s49, s9
    s_mov_b32 s50, 0x10000000
    s_mov_b32 s51, 0x00020000
    s_mov_b32 s20, s10
    s_mov_b32 s21, s11
    s_mov_b32 s22, 0x40000
    s_mov_b32 s23, 0x00020000
    s_mov_b32 s24, s12
    s_mov_b32 s25, s13
    s_mov_b32 s26, 0x40000
    s_mov_b32 s27, 0x00020000
    s_lshr_b32 s38, s2, 3
    s_and_b32 s38, s38, 31
    s_lshl_b32 s38, s38, 3
    s_add_u32 s38, s38, s3
    s_lshl_b32 s38, s38, 10
    v_lshlrev_b32 v57, 4, v0
    buffer_load_dwordx4 v[32:35], v57, s[20:23], s38 offen
    buffer_load_dwordx4 v[36:39], v57, s[24:27], s38 offen
    v_and_b32 v29, 7, v5
    v_lshrrev_b32 v30, 3, v5
    v_lshlrev_b32 v2, 12, v29
    v_lshl_add_u32 v2, v30, 6, v2
    v_lshl_add_u32 v2, v6, 4, v2
    v_lshlrev_b32 v3, 16, v6
    v_lshl_add_u32 v3, v30, 10, v3
    v_lshl_add_u32 v3, v29, 4, v3
    s_mov_b32 s40, 0x07060302
    s_mov_b32 s41, 0xffff0000
    s_mov_b32 s42, 0x3e0293ee
    s_cmp_eq_u32 s36, 0
    s_mov_b32 s54, 0xcccccccc
    s_cselect_b32 s54, s54, 0x33333333
    s_mov_b32 s55, s54
    s_lshl_b32 s38, s36, 6
    v_xor_b32 v3, s38, v3
    v_xor_b32 v3, s86, v3
    s_add_u32 s43, s46, s38
    s_xor_b32 s72, s43, 64
    v_and_b32 v4, 1, v5
    v_mul_u32_u24 v28, 16, v4
    v_sub_u32 v4, 0, v4
    v_and_b32 v4, 0xffff0000, v4
    v_mul_u32_u24 v29, 0x0202, v30
    v_sub_u32 v29, 0x0302, v29
    v_lshlrev_b32 v29, v28, v29
    v_mov_b32 v30, 0x0c0c0000
    v_lshrrev_b32 v30, v28, v30
    v_or_b32 v29, v29, v30
    v_bfe_u32 v30, v5, 1, 2
    v_mov_b32 v31, 0x0c0c0c0c
    v_cmp_eq_u32 vcc, 0, v30
    s_nop 1
    v_cndmask_b32 v8, v31, v29, vcc
    v_cmp_eq_u32 vcc, 1, v30
    s_nop 1
    v_cndmask_b32 v9, v31, v29, vcc
    v_cmp_eq_u32 vcc, 2, v30
    s_nop 1
    v_cndmask_b32 v10, v31, v29, vcc
    v_cmp_eq_u32 vcc, 3, v30
    s_nop 1
    v_cndmask_b32 v11, v31, v29, vcc
    s_mov_b32 s78, 0x100000
    s_mov_b32 s79, 0x00020000
    s_and_b32 s38, s2, 7
    s_lshr_b32 s37, s2, 3
    v_lshl_add_u32 v52, v5, 1, 1
    v_mul_u32_u24 v52, s38, v52
    v_add_u32 v52, s37, v52
    v_and_b32 v52, 31, v52
    v_mul_u32_u24 v55, 11, v5
    v_lshrrev_b32 v55, 5, v55
    v_mul_u32_u24 v55, 3, v55
    v_sub_u32 v55, v5, v55
    v_lshrrev_b32 v55, v55, s38
    v_and_b32 v55, 1, v55
    v_lshl_add_u32 v52, v52, 1, v55
    v_lshl_add_u32 v52, v5, 6, v52
    v_lshlrev_b32 v52, 8, v52
    s_cmp_eq_u32 s3, 0
    s_mov_b32 s38, 0x80000
    s_cselect_b32 s38, s38, 0x7ff00000
    v_add_u32 v52, s38, v52
    v_mov_b32 v54, 1
    v_mov_b32 v56, 0
    v_mov_b32 v55, 2
    s_mov_b32 s75, 2
    s_mov_b32 s84, 0
    s_mov_b64 exec, 0xffff
    buffer_load_dword v53, v52, s[76:79], 0 offen sc1
    s_mov_b64 exec, -1
    ds_write_b32 v56, v55 offset:11264
    s_waitcnt vmcnt(5)
    s_waitcnt vmcnt(7)
    buffer_load_dwordx4 v[76:79], v1, s[16:19], s34 offen offset:768 nt
    s_waitcnt vmcnt(5)
    buffer_load_dwordx4 v[80:83], v1, s[16:19], s34 offen offset:1024 nt
    s_xor_b32 s37, s85, 0
    buffer_load_dwordx4 v[192:195], v2, s[20:23], s37 offen offset:0
    v_dot2_f32_bf16 v20, v64, v12, 0
    v_dot2_f32_bf16 v20, v65, v13, v20
    v_dot2_f32_bf16 v20, v66, v14, v20
    v_dot2_f32_bf16 v20, v67, v15, v20
    s_waitcnt vmcnt(7)
    s_cmp_ge_u32 s75, 4
    s_cbranch_scc1 L_d0
    s_waitcnt vmcnt(6)
    s_cmp_gt_u32 s75, 0
    s_cbranch_scc1 L_d0
    s_waitcnt vmcnt(2)
L_d0:
    buffer_load_dwordx4 v[84:87], v1, s[16:19], s34 offen offset:1280 nt
    v_dot2_f32_bf16 v21, v68, v12, 0
    v_dot2_f32_bf16 v21, v69, v13, v21
    v_dot2_f32_bf16 v21, v70, v14, v21
    v_dot2_f32_bf16 v21, v71, v15, v21
    v_add_f32_dpp v20, v20, v20 row_ror:8 row_mask:0xf bank_mask:0x3
    s_waitcnt vmcnt(3)
    buffer_load_dwordx4 v[88:91], v1, s[16:19], s34 offen offset:1536 nt
    v_dot2_f32_bf16 v22, v72, v12, 0
    v_dot2_f32_bf16 v22, v73, v13, v22
    v_dot2_f32_bf16 v22, v74, v14, v22
    v_dot2_f32_bf16 v22, v75, v15, v22
    v_add_f32_dpp v21, v21, v21 row_ror:8 row_mask:0xf bank_mask:0x3
    s_waitcnt vmcnt(4)
    s_cmp_ge_u32 s75, 3
    s_cbranch_scc1 L_d1
    s_waitcnt vmcnt(3)
    s_cmp_gt_u32 s75, 1
    s_cbranch_scc1 L_d1
    s_waitcnt vmcnt(1)
L_d1:
    buffer_load_dwordx4 v[92:95], v1, s[16:19], s34 offen offset:1792 nt
    s_xor_b32 s37, s85, 32768
    buffer_load_dwordx4 v[196:199], v2, s[20:23], s37 offen offset:0
    v_dot2_f32_bf16 v23, v76, v12, 0
    v_dot2_f32_bf16 v23, v77, v13, v23
    v_dot2_f32_bf16 v23, v78, v14, v23
    v_dot2_f32_bf16 v23, v79, v15, v23
    v_add_f32_dpp v22, v22, v22 row_ror:8 row_mask:0xf bank_mask:0x3
    s_waitcnt vmcnt(3)
    buffer_load_dwordx4 v[96:99], v1, s[16:19], s35 offen offset:0 nt
    v_dot2_f32_bf16 v24, v80, v12, 0
    v_dot2_f32_bf16 v24, v81, v13, v24
    v_dot2_f32_bf16 v24, v82, v14, v24
    v_dot2_f32_bf16 v24, v83, v15, v24
    v_add_f32_dpp v23, v23, v23 row_ror:8 row_mask:0xf bank_mask:0x3
    s_waitcnt vmcnt(4)
    s_cmp_ge_u32 s75, 4
    s_cbranch_scc1 L_d2
    s_waitcnt vmcnt(3)
    s_cmp_gt_u32 s75, 0
    s_cbranch_scc1 L_d2
    s_waitcnt vmcnt(2)
L_d2:
    buffer_load_dwordx4 v[100:103], v1, s[16:19], s35 offen offset:256 nt
    v_dot2_f32_bf16 v25, v84, v12, 0
    v_dot2_f32_bf16 v25, v85, v13, v25
    v_dot2_f32_bf16 v25, v86, v14, v25
    v_dot2_f32_bf16 v25, v87, v15, v25
    v_add_f32_dpp v24, v24, v24 row_ror:8 row_mask:0xf bank_mask:0x3
    s_waitcnt vmcnt(3)
    buffer_load_dwordx4 v[104:107], v1, s[16:19], s35 offen offset:512 nt
    s_xor_b32 s37, s85, 65536
    buffer_load_dwordx4 v[200:203], v2, s[20:23], s37 offen offset:0
    v_dot2_f32_bf16 v26, v88, v12, 0
    v_dot2_f32_bf16 v26, v89, v13, v26
    v_dot2_f32_bf16 v26, v90, v14, v26
    v_dot2_f32_bf16 v26, v91, v15, v26
    v_add_f32_dpp v25, v25, v25 row_ror:8 row_mask:0xf bank_mask:0x3
    s_waitcnt vmcnt(5)
    s_cmp_ge_u32 s75, 3
    s_cbranch_scc1 L_d3
    s_waitcnt vmcnt(3)
    s_cmp_gt_u32 s75, 1
    s_cbranch_scc1 L_d3
    s_waitcnt vmcnt(2)
L_d3:
    buffer_load_dwordx4 v[108:111], v1, s[16:19], s35 offen offset:768 nt
    v_dot2_f32_bf16 v27, v92, v12, 0
    v_dot2_f32_bf16 v27, v93, v13, v27
    v_dot2_f32_bf16 v27, v94, v14, v27
    v_dot2_f32_bf16 v27, v95, v15, v27
    v_add_f32_dpp v26, v26, v26 row_ror:8 row_mask:0xf bank_mask:0x3
    s_waitcnt vmcnt(3)
    buffer_load_dwordx4 v[112:115], v1, s[16:19], s35 offen offset:1024 nt
    v_dot2_f32_bf16 v28, v96, v16, 0
    v_dot2_f32_bf16 v28, v97, v17, v28
    v_dot2_f32_bf16 v28, v98, v18, v28
    v_dot2_f32_bf16 v28, v99, v19, v28
    v_add_f32_dpp v27, v27, v27 row_ror:8 row_mask:0xf bank_mask:0x3
    s_waitcnt vmcnt(4)
    s_cmp_ge_u32 s75, 4
    s_cbranch_scc1 L_d4
    s_waitcnt vmcnt(3)
    s_cmp_gt_u32 s75, 0
    s_cbranch_scc1 L_d4
    s_waitcnt vmcnt(1)
L_d4:
    buffer_load_dwordx4 v[116:119], v1, s[16:19], s35 offen offset:1280 nt
    s_xor_b32 s37, s85, 98304
    buffer_load_dwordx4 v[204:207], v2, s[20:23], s37 offen offset:0
    v_dot2_f32_bf16 v29, v100, v16, 0
    v_dot2_f32_bf16 v29, v101, v17, v29
    v_dot2_f32_bf16 v29, v102, v18, v29
    v_dot2_f32_bf16 v29, v103, v19, v29
    v_add_f32_dpp v20, v28, v28 row_ror:8 row_mask:0xf bank_mask:0xc
    s_waitcnt vmcnt(3)
    buffer_load_dwordx4 v[120:123], v1, s[16:19], s35 offen offset:1536 nt
    v_dot2_f32_bf16 v28, v104, v16, 0
    v_dot2_f32_bf16 v28, v105, v17, v28
    v_dot2_f32_bf16 v28, v106, v18, v28
    v_dot2_f32_bf16 v28, v107, v19, v28
    v_add_f32_dpp v20, v20, v20 row_half_mirror row_mask:0xf bank_mask:0xf
    v_add_f32_dpp v21, v29, v29 row_ror:8 row_mask:0xf bank_mask:0xc
    s_waitcnt vmcnt(4)
    s_cmp_ge_u32 s75, 3
    s_cbranch_scc1 L_d5
    s_waitcnt vmcnt(3)
    s_cmp_gt_u32 s75, 1
    s_cbranch_scc1 L_d5
    s_waitcnt vmcnt(2)
L_d5:
    buffer_load_dwordx4 v[124:127], v1, s[16:19], s35 offen offset:1792 nt
    v_dot2_f32_bf16 v29, v108, v16, 0
    v_dot2_f32_bf16 v29, v109, v17, v29
    v_dot2_f32_bf16 v29, v110, v18, v29
    v_dot2_f32_bf16 v29, v111, v19, v29
    v_add_f32_dpp v20, v20, v20 quad_perm:[1,0,3,2] row_mask:0xf bank_mask:0xf
    v_add_f32_dpp v21, v21, v21 row_half_mirror row_mask:0xf bank_mask:0xf
    v_add_f32_dpp v22, v28, v28 row_ror:8 row_mask:0xf bank_mask:0xc
    s_waitcnt vmcnt(3)
    s_xor_b32 s52, s33, 0
    s_add_u32 s53, s52, 0x80000
    buffer_load_dwordx4 v[64:67], v1, s[16:19], s52 offen offset:0 nt
    s_add_u32 s38, s46, 0
    buffer_load_dwordx4 v[128:131], v3, s[24:27], s38 offen offset:0
    v_dot2_f32_bf16 v28, v112, v16, 0
    v_dot2_f32_bf16 v28, v113, v17, v28
    v_dot2_f32_bf16 v28, v114, v18, v28
    v_dot2_f32_bf16 v28, v115, v19, v28
    v_add_f32_dpp v20, v20, v20 quad_perm:[2,3,0,1] row_mask:0xf bank_mask:0xf
    v_add_f32_dpp v21, v21, v21 quad_perm:[1,0,3,2] row_mask:0xf bank_mask:0xf
    v_add_f32_dpp v22, v22, v22 row_half_mirror row_mask:0xf bank_mask:0xf
    v_add_f32_dpp v23, v29, v29 row_ror:8 row_mask:0xf bank_mask:0xc
    s_waitcnt vmcnt(5)
    s_cmp_ge_u32 s75, 4
    s_cbranch_scc1 L_d6
    s_waitcnt vmcnt(3)
    s_cmp_gt_u32 s75, 0
    s_cbranch_scc1 L_d6
    s_waitcnt vmcnt(2)
L_d6:
    buffer_load_dwordx4 v[68:71], v1, s[16:19], s52 offen offset:256 nt
    v_dot2_f32_bf16 v29, v116, v16, 0
    v_dot2_f32_bf16 v29, v117, v17, v29
    v_dot2_f32_bf16 v29, v118, v18, v29
    v_dot2_f32_bf16 v29, v119, v19, v29
    v_and_b32 v30, v20, v4
    v_sub_f32 v20, v20, v30
    v_add_f32_dpp v21, v21, v21 quad_perm:[2,3,0,1] row_mask:0xf bank_mask:0xf
    v_add_f32_dpp v22, v22, v22 quad_perm:[1,0,3,2] row_mask:0xf bank_mask:0xf
    v_add_f32_dpp v23, v23, v23 row_half_mirror row_mask:0xf bank_mask:0xf
    v_add_f32_dpp v24, v28, v28 row_ror:8 row_mask:0xf bank_mask:0xc
    s_waitcnt vmcnt(3)
    buffer_load_dwordx4 v[72:75], v1, s[16:19], s52 offen offset:512 nt
    s_xor_b32 s37, s85, 131072
    buffer_load_dwordx4 v[208:211], v2, s[20:23], s37 offen offset:0
    v_dot2_f32_bf16 v28, v120, v16, 0
    v_dot2_f32_bf16 v28, v121, v17, v28
    v_dot2_f32_bf16 v28, v122, v18, v28
    v_dot2_f32_bf16 v28, v123, v19, v28
    v_and_b32 v31, v21, v4
    v_sub_f32 v21, v21, v31
    v_add_f32_dpp v22, v22, v22 quad_perm:[2,3,0,1] row_mask:0xf bank_mask:0xf
    v_add_f32_dpp v23, v23, v23 quad_perm:[1,0,3,2] row_mask:0xf bank_mask:0xf
    v_add_f32_dpp v24, v24, v24 row_half_mirror row_mask:0xf bank_mask:0xf
    v_add_f32_dpp v25, v29, v29 row_ror:8 row_mask:0xf bank_mask:0xc
    s_waitcnt vmcnt(5)
    s_cmp_ge_u32 s75, 3
    s_cbranch_scc1 L_d7
    s_waitcnt vmcnt(4)
    s_cmp_gt_u32 s75, 1
    s_cbranch_scc1 L_d7
    s_waitcnt vmcnt(2)
L_d7:
    buffer_load_dwordx4 v[76:79], v1, s[16:19], s52 offen offset:768 nt
    s_cmp_lg_u32 s3, 0
    s_cbranch_scc1 L_a8
    v_readlane_b32 s83, v52, 0
    s_mov_b32 s43, 1
    s_nop 3
    s_and_b32 s83, s83, 0xfff80
    s_atomic_add s43, s[76:77], s83 glc
L_a8:
    v_dot2_f32_bf16 v29, v124, v16, 0
    v_dot2_f32_bf16 v29, v125, v17, v29
    v_dot2_f32_bf16 v29, v126, v18, v29
    v_dot2_f32_bf16 v29, v127, v19, v29
    v_and_b32 v30, v22, v4
    v_sub_f32 v22, v22, v30
    v_add_f32_dpp v23, v23, v23 quad_perm:[2,3,0,1] row_mask:0xf bank_mask:0xf
    v_add_f32_dpp v24, v24, v24 quad_perm:[1,0,3,2] row_mask:0xf bank_mask:0xf
    v_add_f32_dpp v25, v25, v25 row_half_mirror row_mask:0xf bank_mask:0xf
    v_add_f32_dpp v26, v28, v28 row_ror:8 row_mask:0xf bank_mask:0xc
    v_and_b32 v31, v23, v4
    v_sub_f32 v23, v23, v31
    v_add_f32_dpp v24, v24, v24 quad_perm:[2,3,0,1] row_mask:0xf bank_mask:0xf
    v_add_f32_dpp v25, v25, v25 quad_perm:[1,0,3,2] row_mask:0xf bank_mask:0xf
    v_add_f32_dpp v26, v26, v26 row_half_mirror row_mask:0xf bank_mask:0xf
    v_add_f32_dpp v27, v29, v29 row_ror:8 row_mask:0xf bank_mask:0xc
    v_and_b32 v30, v24, v4
    v_sub_f32 v24, v24, v30
    v_add_f32_dpp v25, v25, v25 quad_perm:[2,3,0,1] row_mask:0xf bank_mask:0xf
    v_add_f32_dpp v26, v26, v26 quad_perm:[1,0,3,2] row_mask:0xf bank_mask:0xf
    v_add_f32_dpp v27, v27, v27 row_half_mirror row_mask:0xf bank_mask:0xf
    v_and_b32 v31, v25, v4
    v_sub_f32 v25, v25, v31
    v_add_f32_dpp v26, v26, v26 quad_perm:[2,3,0,1] row_mask:0xf bank_mask:0xf
    v_add_f32_dpp v27, v27, v27 quad_perm:[1,0,3,2] row_mask:0xf bank_mask:0xf
    v_and_b32 v30, v26, v4
    v_sub_f32 v26, v26, v30
    v_add_f32_dpp v27, v27, v27 quad_perm:[2,3,0,1] row_mask:0xf bank_mask:0xf
    v_and_b32 v31, v27, v4
    v_sub_f32 v27, v27, v31
    v_perm_b32 v48, v21, v20, s40
    v_perm_b32 v49, v23, v22, s40
    v_perm_b32 v50, v25, v24, s40
    v_perm_b32 v51, v27, v26, s40
    s_waitcnt vmcnt(3)
    buffer_load_dwordx4 v[80:83], v1, s[16:19], s52 offen offset:1024 nt
    v_dot2_f32_bf16 v20, v64, v12, 0
    v_dot2_f32_bf16 v20, v65, v13, v20
    v_dot2_f32_bf16 v20, v66, v14, v20
    v_dot2_f32_bf16 v20, v67, v15, v20
    s_waitcnt vmcnt(4)
    s_cmp_ge_u32 s75, 4
    s_cbranch_scc1 L_d9
    s_waitcnt vmcnt(3)
    s_cmp_gt_u32 s75, 0
    s_cbranch_scc1 L_d9
    s_waitcnt vmcnt(1)
L_d9:
    buffer_load_dwordx4 v[84:87], v1, s[16:19], s52 offen offset:1280 nt
    s_xor_b32 s37, s85, 163840
    buffer_load_dwordx4 v[212:215], v2, s[20:23], s37 offen offset:0
    v_dot2_f32_bf16 v21, v68, v12, 0
    v_dot2_f32_bf16 v21, v69, v13, v21
    v_dot2_f32_bf16 v21, v70, v14, v21
    v_dot2_f32_bf16 v21, v71, v15, v21
    v_add_f32_dpp v20, v20, v20 row_ror:8 row_mask:0xf bank_mask:0x3
    s_waitcnt vmcnt(3)
    buffer_load_dwordx4 v[88:91], v1, s[16:19], s52 offen offset:1536 nt
    v_dot2_f32_bf16 v22, v72, v12, 0
    v_dot2_f32_bf16 v22, v73, v13, v22
    v_dot2_f32_bf16 v22, v74, v14, v22
    v_dot2_f32_bf16 v22, v75, v15, v22
    v_add_f32_dpp v21, v21, v21 row_ror:8 row_mask:0xf bank_mask:0x3
    s_waitcnt vmcnt(4)
    s_cmp_ge_u32 s75, 3
    s_cbranch_scc1 L_d10
    s_waitcnt vmcnt(3)
    s_cmp_gt_u32 s75, 1
    s_cbranch_scc1 L_d10
    s_waitcnt vmcnt(2)
L_d10:
    buffer_load_dwordx4 v[92:95], v1, s[16:19], s52 offen offset:1792 nt
    v_dot2_f32_bf16 v23, v76, v12, 0
    v_dot2_f32_bf16 v23, v77, v13, v23
    v_dot2_f32_bf16 v23, v78, v14, v23
    v_dot2_f32_bf16 v23, v79, v15, v23
    v_add_f32_dpp v22, v22, v22 row_ror:8 row_mask:0xf bank_mask:0x3
    s_waitcnt vmcnt(3)
    buffer_load_dwordx4 v[96:99], v1, s[16:19], s53 offen offset:0 nt
    s_xor_b32 s37, s85, 196608
    buffer_load_dwordx4 v[216:219], v2, s[20:23], s37 offen offset:0
    v_dot2_f32_bf16 v24, v80, v12, 0
    v_dot2_f32_bf16 v24, v81, v13, v24
    v_dot2_f32_bf16 v24, v82, v14, v24
    v_dot2_f32_bf16 v24, v83, v15, v24
    v_add_f32_dpp v23, v23, v23 row_ror:8 row_mask:0xf bank_mask:0x3
    s_waitcnt vmcnt(5)
    s_cmp_ge_u32 s75, 4
    s_cbranch_scc1 L_d11
    s_waitcnt vmcnt(3)
    s_cmp_gt_u32 s75, 0
    s_cbranch_scc1 L_d11
    s_waitcnt vmcnt(2)
L_d11:
    buffer_load_dwordx4 v[100:103], v1, s[16:19], s53 offen offset:256 nt
    v_readlane_b32 s82, v53, 0
    s_waitcnt lgkmcnt(0)
    s_sub_u32 s43, s43, s82
    s_min_u32 s43, s43, 3
    s_lshl_b32 s43, s43, 2
    s_lshr_b32 s43, 0x3221, s43
    s_and_b32 s43, s43, 7
    v_mov_b32 v55, s43
    s_cmp_lg_u32 s3, 0
    s_cbranch_scc1 L_w12
    ds_write_b32 v56, v55 offset:11264
L_w12:
    v_dot2_f32_bf16 v25, v84, v12, 0
    v_dot2_f32_bf16 v25, v85, v13, v25
    v_dot2_f32_bf16 v25, v86, v14, v25
    v_dot2_f32_bf16 v25, v87, v15, v25
    v_add_f32_dpp v24, v24, v24 row_ror:8 row_mask:0xf bank_mask:0x3
    s_waitcnt vmcnt(3)
    buffer_load_dwordx4 v[104:107], v1, s[16:19], s53 offen offset:512 nt
    v_dot2_f32_bf16 v26, v88, v12, 0
    v_dot2_f32_bf16 v26, v89, v13, v26
    v_dot2_f32_bf16 v26, v90, v14, v26
    v_dot2_f32_bf16 v26, v91, v15, v26
    v_add_f32_dpp v25, v25, v25 row_ror:8 row_mask:0xf bank_mask:0x3
    s_waitcnt vmcnt(4)
    s_cmp_ge_u32 s75, 3
    s_cbranch_scc1 L_d13
    s_waitcnt vmcnt(3)
    s_cmp_gt_u32 s75, 1
    s_cbranch_scc1 L_d13
    s_waitcnt vmcnt(1)
L_d13:
    buffer_load_dwordx4 v[108:111], v1, s[16:19], s53 offen offset:768 nt
    s_xor_b32 s37, s85, 229376
    buffer_load_dwordx4 v[220:223], v2, s[20:23], s37 offen offset:0
    v_dot2_f32_bf16 v27, v92, v12, 0
    v_dot2_f32_bf16 v27, v93, v13, v27
    v_dot2_f32_bf16 v27, v94, v14, v27
    v_dot2_f32_bf16 v27, v95, v15, v27
    v_add_f32_dpp v26, v26, v26 row_ror:8 row_mask:0xf bank_mask:0x3
    s_waitcnt vmcnt(3)
    buffer_load_dwordx4 v[112:115], v1, s[16:19], s53 offen offset:1024 nt
    ds_read_b32 v55, v56 offset:11264
    v_dot2_f32_bf16 v28, v96, v16, 0
    v_dot2_f32_bf16 v28, v97, v17, v28
    v_dot2_f32_bf16 v28, v98, v18, v28
    v_dot2_f32_bf16 v28, v99, v19, v28
    v_add_f32_dpp v27, v27, v27 row_ror:8 row_mask:0xf bank_mask:0x3
    s_waitcnt vmcnt(4)
    s_cmp_ge_u32 s75, 4
    s_cbranch_scc1 L_d14
    s_waitcnt vmcnt(3)
    s_cmp_gt_u32 s75, 0
    s_cbranch_scc1 L_d14
    s_waitcnt vmcnt(2)
L_d14:
    buffer_load_dwordx4 v[116:119], v1, s[16:19], s53 offen offset:1280 nt
    s_waitcnt lgkmcnt(0)
    v_readfirstlane_b32 s75, v55
    s_nop 0
    v_dot2_f32_bf16 v29, v100, v16, 0
    v_dot2_f32_bf16 v29, v101, v17, v29
    v_dot2_f32_bf16 v29, v102, v18, v29
    v_dot2_f32_bf16 v29, v103, v19, v29
    v_add_f32_dpp v20, v28, v28 row_ror:8 row_mask:0xf bank_mask:0xc
    s_waitcnt vmcnt(3)
    buffer_load_dwordx4 v[120:123], v1, s[16:19], s53 offen offset:1536 nt
    s_add_u32 s38, s46, 4096
    buffer_load_dwordx4 v[132:135], v3, s[24:27], s38 offen offset:0
    v_dot2_f32_bf16 v28, v104, v16, 0
    v_dot2_f32_bf16 v28, v105, v17, v28
    v_dot2_f32_bf16 v28, v106, v18, v28
    v_dot2_f32_bf16 v28, v107, v19, v28
    v_add_f32_dpp v20, v20, v20 row_half_mirror row_mask:0xf bank_mask:0xf
    v_add_f32_dpp v21, v29, v29 row_ror:8 row_mask:0xf bank_mask:0xc
    s_waitcnt vmcnt(5)
    s_cmp_ge_u32 s75, 3
    s_cbranch_scc1 L_d15
    s_waitcnt vmcnt(3)
    s_cmp_gt_u32 s75, 1
    s_cbranch_scc1 L_d15
    s_waitcnt vmcnt(2)
L_d15:
    buffer_load_dwordx4 v[124:127], v1, s[16:19], s53 offen offset:1792 nt
    v_dot2_f32_bf16 v29, v108, v16, 0
    v_dot2_f32_bf16 v29, v109, v17, v29
    v_dot2_f32_bf16 v29, v110, v18, v29
    v_dot2_f32_bf16 v29, v111, v19, v29
    v_add_f32_dpp v20, v20, v20 quad_perm:[1,0,3,2] row_mask:0xf bank_mask:0xf
    v_add_f32_dpp v21, v21, v21 row_half_mirror row_mask:0xf bank_mask:0xf
    v_add_f32_dpp v22, v28, v28 row_ror:8 row_mask:0xf bank_mask:0xc
    s_waitcnt vmcnt(3)
    s_xor_b32 s34, s32, 131072
    s_add_u32 s35, s34, 0x80000
    buffer_load_dwordx4 v[64:67], v1, s[16:19], s34 offen offset:0 nt
    s_add_u32 s38, s46, 8192
    buffer_load_dwordx4 v[136:139], v3, s[24:27], s38 offen offset:0
    v_dot2_f32_bf16 v28, v112, v16, 0
    v_dot2_f32_bf16 v28, v113, v17, v28
    v_dot2_f32_bf16 v28, v114, v18, v28
    v_dot2_f32_bf16 v28, v115, v19, v28
    v_add_f32_dpp v20, v20, v20 quad_perm:[2,3,0,1] row_mask:0xf bank_mask:0xf
    v_add_f32_dpp v21, v21, v21 quad_perm:[1,0,3,2] row_mask:0xf bank_mask:0xf
    v_add_f32_dpp v22, v22, v22 row_half_mirror row_mask:0xf bank_mask:0xf
    v_add_f32_dpp v23, v29, v29 row_ror:8 row_mask:0xf bank_mask:0xc
    s_waitcnt vmcnt(5)
    s_cmp_ge_u32 s75, 4
    s_cbranch_scc1 L_d16
    s_waitcnt vmcnt(4)
    s_cmp_gt_u32 s75, 0
    s_cbranch_scc1 L_d16
    s_waitcnt vmcnt(2)
L_d16:
    buffer_load_dwordx4 v[68:71], v1, s[16:19], s34 offen offset:256 nt
    v_dot2_f32_bf16 v29, v116, v16, 0
    v_dot2_f32_bf16 v29, v117, v17, v29
    v_dot2_f32_bf16 v29, v118, v18, v29
    v_dot2_f32_bf16 v29, v119, v19, v29
    v_and_b32 v30, v20, v4
    v_sub_f32 v20, v20, v30
    v_add_f32_dpp v21, v21, v21 quad_perm:[2,3,0,1] row_mask:0xf bank_mask:0xf
    v_add_f32_dpp v22, v22, v22 quad_perm:[1,0,3,2] row_mask:0xf bank_mask:0xf
    v_add_f32_dpp v23, v23, v23 row_half_mirror row_mask:0xf bank_mask:0xf
    v_add_f32_dpp v24, v28, v28 row_ror:8 row_mask:0xf bank_mask:0xc
    s_waitcnt vmcnt(3)
    buffer_load_dwordx4 v[72:75], v1, s[16:19], s34 offen offset:512 nt
    s_add_u32 s38, s46, 12288
    buffer_load_dwordx4 v[140:143], v3, s[24:27], s38 offen offset:0
    v_dot2_f32_bf16 v28, v120, v16, 0
    v_dot2_f32_bf16 v28, v121, v17, v28
    v_dot2_f32_bf16 v28, v122, v18, v28
    v_dot2_f32_bf16 v28, v123, v19, v28
    v_and_b32 v31, v21, v4
    v_sub_f32 v21, v21, v31
    v_add_f32_dpp v22, v22, v22 quad_perm:[2,3,0,1] row_mask:0xf bank_mask:0xf
    v_add_f32_dpp v23, v23, v23 quad_perm:[1,0,3,2] row_mask:0xf bank_mask:0xf
    v_add_f32_dpp v24, v24, v24 row_half_mirror row_mask:0xf bank_mask:0xf
    v_add_f32_dpp v25, v29, v29 row_ror:8 row_mask:0xf bank_mask:0xc
    s_waitcnt vmcnt(5)
    s_cmp_ge_u32 s75, 3
    s_cbranch_scc1 L_d17
    s_waitcnt vmcnt(4)
    s_cmp_gt_u32 s75, 1
    s_cbranch_scc1 L_d17
    s_waitcnt vmcnt(2)
L_d17:
    buffer_load_dwordx4 v[76:79], v1, s[16:19], s34 offen offset:768 nt
    s_cmp_lg_u32 s3, 0
    s_cbranch_scc1 L_a18
    v_readlane_b32 s83, v52, 1
    s_mov_b32 s43, 1
    s_nop 3
    s_and_b32 s83, s83, 0xfff80
    s_atomic_add s43, s[76:77], s83 glc
L_a18:
    v_dot2_f32_bf16 v29, v124, v16, 0
    v_dot2_f32_bf16 v29, v125, v17, v29
    v_dot2_f32_bf16 v29, v126, v18, v29
    v_dot2_f32_bf16 v29, v127, v19, v29
    v_and_b32 v30, v22, v4
    v_sub_f32 v22, v22, v30
    v_add_f32_dpp v23, v23, v23 quad_perm:[2,3,0,1] row_mask:0xf bank_mask:0xf
    v_add_f32_dpp v24, v24, v24 quad_perm:[1,0,3,2] row_mask:0xf bank_mask:0xf
    v_add_f32_dpp v25, v25, v25 row_half_mirror row_mask:0xf bank_mask:0xf
    v_add_f32_dpp v26, v28, v28 row_ror:8 row_mask:0xf bank_mask:0xc
    v_and_b32 v31, v23, v4
    v_sub_f32 v23, v23, v31
    v_add_f32_dpp v24, v24, v24 quad_perm:[2,3,0,1] row_mask:0xf bank_mask:0xf
    v_add_f32_dpp v25, v25, v25 quad_perm:[1,0,3,2] row_mask:0xf bank_mask:0xf
    v_add_f32_dpp v26, v26, v26 row_half_mirror row_mask:0xf bank_mask:0xf
    v_add_f32_dpp v27, v29, v29 row_ror:8 row_mask:0xf bank_mask:0xc
    v_and_b32 v30, v24, v4
    v_sub_f32 v24, v24, v30
    v_add_f32_dpp v25, v25, v25 quad_perm:[2,3,0,1] row_mask:0xf bank_mask:0xf
    v_add_f32_dpp v26, v26, v26 quad_perm:[1,0,3,2] row_mask:0xf bank_mask:0xf
    v_add_f32_dpp v27, v27, v27 row_half_mirror row_mask:0xf bank_mask:0xf
    v_and_b32 v31, v25, v4
    v_sub_f32 v25, v25, v31
    v_add_f32_dpp v26, v26, v26 quad_perm:[2,3,0,1] row_mask:0xf bank_mask:0xf
    v_add_f32_dpp v27, v27, v27 quad_perm:[1,0,3,2] row_mask:0xf bank_mask:0xf
    v_and_b32 v30, v26, v4
    v_sub_f32 v26, v26, v30
    v_add_f32_dpp v27, v27, v27 quad_perm:[2,3,0,1] row_mask:0xf bank_mask:0xf
    v_and_b32 v31, v27, v4
    v_sub_f32 v27, v27, v31
    v_perm_b32 v20, v21, v20, s40
    v_perm_b32 v21, v23, v22, s40
    v_perm_b32 v22, v25, v24, s40
    v_perm_b32 v23, v27, v26, s40
    v_cndmask_b32 v48, v48, v20, s[54:55]
    v_cndmask_b32 v49, v49, v21, s[54:55]
    v_cndmask_b32 v50, v50, v22, s[54:55]
    v_cndmask_b32 v51, v51, v23, s[54:55]
    s_waitcnt vmcnt(11)
    s_nop 0
    v_mfma_f32_16x16x32_bf16 v[224:227], v[192:195], v[48:51], 0
    v_mfma_f32_16x16x32_bf16 v[228:231], v[196:199], v[48:51], 0
    v_mfma_f32_16x16x32_bf16 v[232:235], v[200:203], v[48:51], 0
    v_mfma_f32_16x16x32_bf16 v[236:239], v[204:207], v[48:51], 0
    v_mfma_f32_16x16x32_bf16 v[240:243], v[208:211], v[48:51], 0
    v_mfma_f32_16x16x32_bf16 v[244:247], v[212:215], v[48:51], 0
    v_mfma_f32_16x16x32_bf16 v[248:251], v[216:219], v[48:51], 0
    v_mfma_f32_16x16x32_bf16 v[252:255], v[220:223], v[48:51], 0
    s_waitcnt vmcnt(3)
    buffer_load_dwordx4 v[80:83], v1, s[16:19], s34 offen offset:1024 nt
    s_xor_b32 s37, s85, 1024
    buffer_load_dwordx4 v[192:195], v2, s[20:23], s37 offen offset:0
    v_dot2_f32_bf16 v20, v64, v12, 0
    v_dot2_f32_bf16 v20, v65, v13, v20
    v_dot2_f32_bf16 v20, v66, v14, v20
    v_dot2_f32_bf16 v20, v67, v15, v20
    s_waitcnt vmcnt(5)
    s_cmp_ge_u32 s75, 4
    s_cbranch_scc1 L_d19
    s_waitcnt vmcnt(4)
    s_cmp_gt_u32 s75, 0
    s_cbranch_scc1 L_d19
    s_waitcnt vmcnt(2)
L_d19:
    buffer_load_dwordx4 v[84:87], v1, s[16:19], s34 offen offset:1280 nt
    v_dot2_f32_bf16 v21, v68, v12, 0
    v_dot2_f32_bf16 v21, v69, v13, v21
    v_dot2_f32_bf16 v21, v70, v14, v21
    v_dot2_f32_bf16 v21, v71, v15, v21
    v_add_f32_dpp v20, v20, v20 row_ror:8 row_mask:0xf bank_mask:0x3
    s_waitcnt vmcnt(3)
    buffer_load_dwordx4 v[88:91], v1, s[16:19], s34 offen offset:1536 nt
    v_dot2_f32_bf16 v22, v72, v12, 0
    v_dot2_f32_bf16 v22, v73, v13, v22
    v_dot2_f32_bf16 v22, v74, v14, v22
    v_dot2_f32_bf16 v22, v75, v15, v22
    v_add_f32_dpp v21, v21, v21 row_ror:8 row_mask:0xf bank_mask:0x3
    s_waitcnt vmcnt(4)
    s_cmp_ge_u32 s75, 3
    s_cbranch_scc1 L_d20
    s_waitcnt vmcnt(3)
    s_cmp_gt_u32 s75, 1
    s_cbranch_scc1 L_d20
    s_waitcnt vmcnt(1)
L_d20:
    buffer_load_dwordx4 v[92:95], v1, s[16:19], s34 offen offset:1792 nt
    s_xor_b32 s37, s85, 33792
    buffer_load_dwordx4 v[196:199], v2, s[20:23], s37 offen offset:0
    v_dot2_f32_bf16 v23, v76, v12, 0
    v_dot2_f32_bf16 v23, v77, v13, v23
    v_dot2_f32_bf16 v23, v78, v14, v23
    v_dot2_f32_bf16 v23, v79, v15, v23
    v_add_f32_dpp v22, v22, v22 row_ror:8 row_mask:0xf bank_mask:0x3
    s_waitcnt vmcnt(3)
    buffer_load_dwordx4 v[96:99], v1, s[16:19], s35 offen offset:0 nt
    v_dot2_f32_bf16 v24, v80, v12, 0
    v_dot2_f32_bf16 v24, v81, v13, v24
    v_dot2_f32_bf16 v24, v82, v14, v24
    v_dot2_f32_bf16 v24, v83, v15, v24
    v_add_f32_dpp v23, v23, v23 row_ror:8 row_mask:0xf bank_mask:0x3
    s_waitcnt vmcnt(4)
    s_cmp_ge_u32 s75, 4
    s_cbranch_scc1 L_d21
    s_waitcnt vmcnt(3)
    s_cmp_gt_u32 s75, 0
    s_cbranch_scc1 L_d21
    s_waitcnt vmcnt(2)
L_d21:
    buffer_load_dwordx4 v[100:103], v1, s[16:19], s35 offen offset:256 nt
    v_readlane_b32 s82, v53, 1
    s_waitcnt lgkmcnt(0)
    s_sub_u32 s43, s43, s82
    s_min_u32 s43, s43, 3
    s_lshl_b32 s43, s43, 2
    s_lshr_b32 s43, 0x3221, s43
    s_and_b32 s43, s43, 7
    v_mov_b32 v55, s43
    s_cmp_lg_u32 s3, 0
    s_cbranch_scc1 L_w22
    ds_write_b32 v56, v55 offset:11264
L_w22:
    v_dot2_f32_bf16 v25, v84, v12, 0
    v_dot2_f32_bf16 v25, v85, v13, v25
    v_dot2_f32_bf16 v25, v86, v14, v25
    v_dot2_f32_bf16 v25, v87, v15, v25
    v_add_f32_dpp v24, v24, v24 row_ror:8 row_mask:0xf bank_mask:0x3
    s_waitcnt vmcnt(3)
    buffer_load_dwordx4 v[104:107], v1, s[16:19], s35 offen offset:512 nt
    s_xor_b32 s37, s85, 66560
    buffer_load_dwordx4 v[200:203], v2, s[20:23], s37 offen offset:0
    v_dot2_f32_bf16 v26, v88, v12, 0
    v_dot2_f32_bf16 v26, v89, v13, v26
    v_dot2_f32_bf16 v26, v90, v14, v26
    v_dot2_f32_bf16 v26, v91, v15, v26
    v_add_f32_dpp v25, v25, v25 row_ror:8 row_mask:0xf bank_mask:0x3
    s_waitcnt vmcnt(5)
    s_cmp_ge_u32 s75, 3
    s_cbranch_scc1 L_d23
    s_waitcnt vmcnt(3)
    s_cmp_gt_u32 s75, 1
    s_cbranch_scc1 L_d23
    s_waitcnt vmcnt(2)
L_d23:
    buffer_load_dwordx4 v[108:111], v1, s[16:19], s35 offen offset:768 nt
    v_dot2_f32_bf16 v27, v92, v12, 0
    v_dot2_f32_bf16 v27, v93, v13, v27
    v_dot2_f32_bf16 v27, v94, v14, v27
    v_dot2_f32_bf16 v27, v95, v15, v27
    v_add_f32_dpp v26, v26, v26 row_ror:8 row_mask:0xf bank_mask:0x3
    s_waitcnt vmcnt(3)
    buffer_load_dwordx4 v[112:115], v1, s[16:19], s35 offen offset:1024 nt
    ds_read_b32 v55, v56 offset:11264
    v_dot2_f32_bf16 v28, v96, v16, 0
    v_dot2_f32_bf16 v28, v97, v17, v28
    v_dot2_f32_bf16 v28, v98, v18, v28
    v_dot2_f32_bf16 v28, v99, v19, v28
    v_add_f32_dpp v27, v27, v27 row_ror:8 row_mask:0xf bank_mask:0x3
    s_waitcnt vmcnt(4)
    s_cmp_ge_u32 s75, 4
    s_cbranch_scc1 L_d24
    s_waitcnt vmcnt(3)
    s_cmp_gt_u32 s75, 0
    s_cbranch_scc1 L_d24
    s_waitcnt vmcnt(1)
L_d24:
    buffer_load_dwordx4 v[116:119], v1, s[16:19], s35 offen offset:1280 nt
    s_xor_b32 s37, s85, 99328
    buffer_load_dwordx4 v[204:207], v2, s[20:23], s37 offen offset:0
    s_waitcnt lgkmcnt(0)
    v_readfirstlane_b32 s75, v55
    s_nop 0
    v_dot2_f32_bf16 v29, v100, v16, 0
    v_dot2_f32_bf16 v29, v101, v17, v29
    v_dot2_f32_bf16 v29, v102, v18, v29
    v_dot2_f32_bf16 v29, v103, v19, v29
    v_add_f32_dpp v20, v28, v28 row_ror:8 row_mask:0xf bank_mask:0xc
    s_waitcnt vmcnt(3)
    buffer_load_dwordx4 v[120:123], v1, s[16:19], s35 offen offset:1536 nt
    v_dot2_f32_bf16 v28, v104, v16, 0
    v_dot2_f32_bf16 v28, v105, v17, v28
    v_dot2_f32_bf16 v28, v106, v18, v28
    v_dot2_f32_bf16 v28, v107, v19, v28
    v_add_f32_dpp v20, v20, v20 row_half_mirror row_mask:0xf bank_mask:0xf
    v_add_f32_dpp v21, v29, v29 row_ror:8 row_mask:0xf bank_mask:0xc
    s_waitcnt vmcnt(4)
    s_cmp_ge_u32 s75, 3
    s_cbranch_scc1 L_d25
    s_waitcnt vmcnt(3)
    s_cmp_gt_u32 s75, 1
    s_cbranch_scc1 L_d25
    s_waitcnt vmcnt(2)
L_d25:
    buffer_load_dwordx4 v[124:127], v1, s[16:19], s35 offen offset:1792 nt
    v_dot2_f32_bf16 v29, v108, v16, 0
    v_dot2_f32_bf16 v29, v109, v17, v29
    v_dot2_f32_bf16 v29, v110, v18, v29
    v_dot2_f32_bf16 v29, v111, v19, v29
    v_add_f32_dpp v20, v20, v20 quad_perm:[1,0,3,2] row_mask:0xf bank_mask:0xf
    v_add_f32_dpp v21, v21, v21 row_half_mirror row_mask:0xf bank_mask:0xf
    v_add_f32_dpp v22, v28, v28 row_ror:8 row_mask:0xf bank_mask:0xc
    s_waitcnt vmcnt(3)
    s_xor_b32 s52, s33, 131072
    s_add_u32 s53, s52, 0x80000
    buffer_load_dwordx4 v[64:67], v1, s[16:19], s52 offen offset:0 nt
    s_add_u32 s38, s46, 16384
    buffer_load_dwordx4 v[144:147], v3, s[24:27], s38 offen offset:0
    v_dot2_f32_bf16 v28, v112, v16, 0
    v_dot2_f32_bf16 v28, v113, v17, v28
    v_dot2_f32_bf16 v28, v114, v18, v28
    v_dot2_f32_bf16 v28, v115, v19, v28
    v_add_f32_dpp v20, v20, v20 quad_perm:[2,3,0,1] row_mask:0xf bank_mask:0xf
    v_add_f32_dpp v21, v21, v21 quad_perm:[1,0,3,2] row_mask:0xf bank_mask:0xf
    v_add_f32_dpp v22, v22, v22 row_half_mirror row_mask:0xf bank_mask:0xf
    v_add_f32_dpp v23, v29, v29 row_ror:8 row_mask:0xf bank_mask:0xc
    s_waitcnt vmcnt(5)
    s_cmp_ge_u32 s75, 4
    s_cbranch_scc1 L_d26
    s_waitcnt vmcnt(3)
    s_cmp_gt_u32 s75, 0
    s_cbranch_scc1 L_d26
    s_waitcnt vmcnt(2)
L_d26:
    buffer_load_dwordx4 v[68:71], v1, s[16:19], s52 offen offset:256 nt
    v_dot2_f32_bf16 v29, v116, v16, 0
    v_dot2_f32_bf16 v29, v117, v17, v29
    v_dot2_f32_bf16 v29, v118, v18, v29
    v_dot2_f32_bf16 v29, v119, v19, v29
    v_and_b32 v30, v20, v4
    v_sub_f32 v20, v20, v30
    v_add_f32_dpp v21, v21, v21 quad_perm:[2,3,0,1] row_mask:0xf bank_mask:0xf
    v_add_f32_dpp v22, v22, v22 quad_perm:[1,0,3,2] row_mask:0xf bank_mask:0xf
    v_add_f32_dpp v23, v23, v23 row_half_mirror row_mask:0xf bank_mask:0xf
    v_add_f32_dpp v24, v28, v28 row_ror:8 row_mask:0xf bank_mask:0xc
    s_waitcnt vmcnt(3)
    buffer_load_dwordx4 v[72:75], v1, s[16:19], s52 offen offset:512 nt
    s_xor_b32 s37, s85, 132096
    buffer_load_dwordx4 v[208:211], v2, s[20:23], s37 offen offset:0
    v_dot2_f32_bf16 v28, v120, v16, 0
    v_dot2_f32_bf16 v28, v121, v17, v28
    v_dot2_f32_bf16 v28, v122, v18, v28
    v_dot2_f32_bf16 v28, v123, v19, v28
    v_and_b32 v31, v21, v4
    v_sub_f32 v21, v21, v31
    v_add_f32_dpp v22, v22, v22 quad_perm:[2,3,0,1] row_mask:0xf bank_mask:0xf
    v_add_f32_dpp v23, v23, v23 quad_perm:[1,0,3,2] row_mask:0xf bank_mask:0xf
    v_add_f32_dpp v24, v24, v24 row_half_mirror row_mask:0xf bank_mask:0xf
    v_add_f32_dpp v25, v29, v29 row_ror:8 row_mask:0xf bank_mask:0xc
    s_waitcnt vmcnt(5)
    s_cmp_ge_u32 s75, 3
    s_cbranch_scc1 L_d27
    s_waitcnt vmcnt(4)
    s_cmp_gt_u32 s75, 1
    s_cbranch_scc1 L_d27
    s_waitcnt vmcnt(2)
L_d27:
    buffer_load_dwordx4 v[76:79], v1, s[16:19], s52 offen offset:768 nt
    s_cmp_lg_u32 s3, 0
    s_cbranch_scc1 L_a28
    v_readlane_b32 s83, v52, 2
    s_mov_b32 s43, 1
    s_nop 3
    s_and_b32 s83, s83, 0xfff80
    s_atomic_add s43, s[76:77], s83 glc
L_a28:
    v_dot2_f32_bf16 v29, v124, v16, 0
    v_dot2_f32_bf16 v29, v125, v17, v29
    v_dot2_f32_bf16 v29, v126, v18, v29
    v_dot2_f32_bf16 v29, v127, v19, v29
    v_and_b32 v30, v22, v4
    v_sub_f32 v22, v22, v30
    v_add_f32_dpp v23, v23, v23 quad_perm:[2,3,0,1] row_mask:0xf bank_mask:0xf
    v_add_f32_dpp v24, v24, v24 quad_perm:[1,0,3,2] row_mask:0xf bank_mask:0xf
    v_add_f32_dpp v25, v25, v25 row_half_mirror row_mask:0xf bank_mask:0xf
    v_add_f32_dpp v26, v28, v28 row_ror:8 row_mask:0xf bank_mask:0xc
    v_and_b32 v31, v23, v4
    v_sub_f32 v23, v23, v31
    v_add_f32_dpp v24, v24, v24 quad_perm:[2,3,0,1] row_mask:0xf bank_mask:0xf
    v_add_f32_dpp v25, v25, v25 quad_perm:[1,0,3,2] row_mask:0xf bank_mask:0xf
    v_add_f32_dpp v26, v26, v26 row_half_mirror row_mask:0xf bank_mask:0xf
    v_add_f32_dpp v27, v29, v29 row_ror:8 row_mask:0xf bank_mask:0xc
    v_and_b32 v30, v24, v4
    v_sub_f32 v24, v24, v30
    v_add_f32_dpp v25, v25, v25 quad_perm:[2,3,0,1] row_mask:0xf bank_mask:0xf
    v_add_f32_dpp v26, v26, v26 quad_perm:[1,0,3,2] row_mask:0xf bank_mask:0xf
    v_add_f32_dpp v27, v27, v27 row_half_mirror row_mask:0xf bank_mask:0xf
    v_and_b32 v31, v25, v4
    v_sub_f32 v25, v25, v31
    v_add_f32_dpp v26, v26, v26 quad_perm:[2,3,0,1] row_mask:0xf bank_mask:0xf
    v_add_f32_dpp v27, v27, v27 quad_perm:[1,0,3,2] row_mask:0xf bank_mask:0xf
    v_and_b32 v30, v26, v4
    v_sub_f32 v26, v26, v30
    v_add_f32_dpp v27, v27, v27 quad_perm:[2,3,0,1] row_mask:0xf bank_mask:0xf
    v_and_b32 v31, v27, v4
    v_sub_f32 v27, v27, v31
    v_perm_b32 v48, v21, v20, s40
    v_perm_b32 v49, v23, v22, s40
    v_perm_b32 v50, v25, v24, s40
    v_perm_b32 v51, v27, v26, s40
    s_waitcnt vmcnt(3)
    buffer_load_dwordx4 v[80:83], v1, s[16:19], s52 offen offset:1024 nt
    v_dot2_f32_bf16 v20, v64, v12, 0
    v_dot2_f32_bf16 v20, v65, v13, v20
    v_dot2_f32_bf16 v20, v66, v14, v20
    v_dot2_f32_bf16 v20, v67, v15, v20
    s_waitcnt vmcnt(4)
    s_cmp_ge_u32 s75, 4
    s_cbranch_scc1 L_d29
    s_waitcnt vmcnt(3)
    s_cmp_gt_u32 s75, 0
    s_cbranch_scc1 L_d29
    s_waitcnt vmcnt(1)
L_d29:
    buffer_load_dwordx4 v[84:87], v1, s[16:19], s52 offen offset:1280 nt
    s_xor_b32 s37, s85, 164864
    buffer_load_dwordx4 v[212:215], v2, s[20:23], s37 offen offset:0
    v_dot2_f32_bf16 v21, v68, v12, 0
    v_dot2_f32_bf16 v21, v69, v13, v21
    v_dot2_f32_bf16 v21, v70, v14, v21
    v_dot2_f32_bf16 v21, v71, v15, v21
    v_add_f32_dpp v20, v20, v20 row_ror:8 row_mask:0xf bank_mask:0x3
    s_waitcnt vmcnt(3)
    buffer_load_dwordx4 v[88:91], v1, s[16:19], s52 offen offset:1536 nt
    v_dot2_f32_bf16 v22, v72, v12, 0
    v_dot2_f32_bf16 v22, v73, v13, v22
    v_dot2_f32_bf16 v22, v74, v14, v22
    v_dot2_f32_bf16 v22, v75, v15, v22
    v_add_f32_dpp v21, v21, v21 row_ror:8 row_mask:0xf bank_mask:0x3
    s_waitcnt vmcnt(4)
    s_cmp_ge_u32 s75, 3
    s_cbranch_scc1 L_d30
    s_waitcnt vmcnt(3)
    s_cmp_gt_u32 s75, 1
    s_cbranch_scc1 L_d30
    s_waitcnt vmcnt(2)
L_d30:
    buffer_load_dwordx4 v[92:95], v1, s[16:19], s52 offen offset:1792 nt
    v_dot2_f32_bf16 v23, v76, v12, 0
    v_dot2_f32_bf16 v23, v77, v13, v23
    v_dot2_f32_bf16 v23, v78, v14, v23
    v_dot2_f32_bf16 v23, v79, v15, v23
    v_add_f32_dpp v22, v22, v22 row_ror:8 row_mask:0xf bank_mask:0x3
    s_waitcnt vmcnt(3)
    buffer_load_dwordx4 v[96:99], v1, s[16:19], s53 offen offset:0 nt
    s_xor_b32 s37, s85, 197632
    buffer_load_dwordx4 v[216:219], v2, s[20:23], s37 offen offset:0
    v_dot2_f32_bf16 v24, v80, v12, 0
    v_dot2_f32_bf16 v24, v81, v13, v24
    v_dot2_f32_bf16 v24, v82, v14, v24
    v_dot2_f32_bf16 v24, v83, v15, v24
    v_add_f32_dpp v23, v23, v23 row_ror:8 row_mask:0xf bank_mask:0x3
    s_waitcnt vmcnt(5)
    s_cmp_ge_u32 s75, 4
    s_cbranch_scc1 L_d31
    s_waitcnt vmcnt(3)
    s_cmp_gt_u32 s75, 0
    s_cbranch_scc1 L_d31
    s_waitcnt vmcnt(2)
L_d31:
    buffer_load_dwordx4 v[100:103], v1, s[16:19], s53 offen offset:256 nt
    v_readlane_b32 s82, v53, 2
    s_waitcnt lgkmcnt(0)
    s_sub_u32 s43, s43, s82
    s_min_u32 s43, s43, 3
    s_lshl_b32 s43, s43, 2
    s_lshr_b32 s43, 0x3221, s43
    s_and_b32 s43, s43, 7
    v_mov_b32 v55, s43
    s_cmp_lg_u32 s3, 0
    s_cbranch_scc1 L_w32
    ds_write_b32 v56, v55 offset:11264
L_w32:
    v_dot2_f32_bf16 v25, v84, v12, 0
    v_dot2_f32_bf16 v25, v85, v13, v25
    v_dot2_f32_bf16 v25, v86, v14, v25
    v_dot2_f32_bf16 v25, v87, v15, v25
    v_add_f32_dpp v24, v24, v24 row_ror:8 row_mask:0xf bank_mask:0x3
    s_waitcnt vmcnt(3)
    buffer_load_dwordx4 v[104:107], v1, s[16:19], s53 offen offset:512 nt
    v_dot2_f32_bf16 v26, v88, v12, 0
    v_dot2_f32_bf16 v26, v89, v13, v26
    v_dot2_f32_bf16 v26, v90, v14, v26
    v_dot2_f32_bf16 v26, v91, v15, v26
    v_add_f32_dpp v25, v25, v25 row_ror:8 row_mask:0xf bank_mask:0x3
    s_waitcnt vmcnt(4)
    s_cmp_ge_u32 s75, 3
    s_cbranch_scc1 L_d33
    s_waitcnt vmcnt(3)
    s_cmp_gt_u32 s75, 1
    s_cbranch_scc1 L_d33
    s_waitcnt vmcnt(1)
L_d33:
    buffer_load_dwordx4 v[108:111], v1, s[16:19], s53 offen offset:768 nt
    s_xor_b32 s37, s85, 230400
    buffer_load_dwordx4 v[220:223], v2, s[20:23], s37 offen offset:0
    v_dot2_f32_bf16 v27, v92, v12, 0
    v_dot2_f32_bf16 v27, v93, v13, v27
    v_dot2_f32_bf16 v27, v94, v14, v27
    v_dot2_f32_bf16 v27, v95, v15, v27
    v_add_f32_dpp v26, v26, v26 row_ror:8 row_mask:0xf bank_mask:0x3
    s_waitcnt vmcnt(3)
    buffer_load_dwordx4 v[112:115], v1, s[16:19], s53 offen offset:1024 nt
    ds_read_b32 v55, v56 offset:11264
    v_dot2_f32_bf16 v28, v96, v16, 0
    v_dot2_f32_bf16 v28, v97, v17, v28
    v_dot2_f32_bf16 v28, v98, v18, v28
    v_dot2_f32_bf16 v28, v99, v19, v28
    v_add_f32_dpp v27, v27, v27 row_ror:8 row_mask:0xf bank_mask:0x3
    s_waitcnt vmcnt(4)
    s_cmp_ge_u32 s75, 4
    s_cbranch_scc1 L_d34
    s_waitcnt vmcnt(3)
    s_cmp_gt_u32 s75, 0
    s_cbranch_scc1 L_d34
    s_waitcnt vmcnt(2)
L_d34:
    buffer_load_dwordx4 v[116:119], v1, s[16:19], s53 offen offset:1280 nt
    s_waitcnt lgkmcnt(0)
    v_readfirstlane_b32 s75, v55
    s_nop 0
    v_dot2_f32_bf16 v29, v100, v16, 0
    v_dot2_f32_bf16 v29, v101, v17, v29
    v_dot2_f32_bf16 v29, v102, v18, v29
    v_dot2_f32_bf16 v29, v103, v19, v29
    v_add_f32_dpp v20, v28, v28 row_ror:8 row_mask:0xf bank_mask:0xc
    s_waitcnt vmcnt(3)
    buffer_load_dwordx4 v[120:123], v1, s[16:19], s53 offen offset:1536 nt
    s_add_u32 s38, s46, 20480
    buffer_load_dwordx4 v[148:151], v3, s[24:27], s38 offen offset:0
    v_dot2_f32_bf16 v28, v104, v16, 0
    v_dot2_f32_bf16 v28, v105, v17, v28
    v_dot2_f32_bf16 v28, v106, v18, v28
    v_dot2_f32_bf16 v28, v107, v19, v28
    v_add_f32_dpp v20, v20, v20 row_half_mirror row_mask:0xf bank_mask:0xf
    v_add_f32_dpp v21, v29, v29 row_ror:8 row_mask:0xf bank_mask:0xc
    s_waitcnt vmcnt(5)
    s_cmp_ge_u32 s75, 3
    s_cbranch_scc1 L_d35
    s_waitcnt vmcnt(3)
    s_cmp_gt_u32 s75, 1
    s_cbranch_scc1 L_d35
    s_waitcnt vmcnt(2)
L_d35:
    buffer_load_dwordx4 v[124:127], v1, s[16:19], s53 offen offset:1792 nt
    v_dot2_f32_bf16 v29, v108, v16, 0
    v_dot2_f32_bf16 v29, v109, v17, v29
    v_dot2_f32_bf16 v29, v110, v18, v29
    v_dot2_f32_bf16 v29, v111, v19, v29
    v_add_f32_dpp v20, v20, v20 quad_perm:[1,0,3,2] row_mask:0xf bank_mask:0xf
    v_add_f32_dpp v21, v21, v21 row_half_mirror row_mask:0xf bank_mask:0xf
    v_add_f32_dpp v22, v28, v28 row_ror:8 row_mask:0xf bank_mask:0xc
    s_waitcnt vmcnt(3)
    s_xor_b32 s34, s32, 262144
    s_add_u32 s35, s34, 0x80000
    buffer_load_dwordx4 v[64:67], v1, s[16:19], s34 offen offset:0 nt
    s_add_u32 s38, s46, 24576
    buffer_load_dwordx4 v[152:155], v3, s[24:27], s38 offen offset:0
    v_dot2_f32_bf16 v28, v112, v16, 0
    v_dot2_f32_bf16 v28, v113, v17, v28
    v_dot2_f32_bf16 v28, v114, v18, v28
    v_dot2_f32_bf16 v28, v115, v19, v28
    v_add_f32_dpp v20, v20, v20 quad_perm:[2,3,0,1] row_mask:0xf bank_mask:0xf
    v_add_f32_dpp v21, v21, v21 quad_perm:[1,0,3,2] row_mask:0xf bank_mask:0xf
    v_add_f32_dpp v22, v22, v22 row_half_mirror row_mask:0xf bank_mask:0xf
    v_add_f32_dpp v23, v29, v29 row_ror:8 row_mask:0xf bank_mask:0xc
    s_waitcnt vmcnt(5)
    s_cmp_ge_u32 s75, 4
    s_cbranch_scc1 L_d36
    s_waitcnt vmcnt(4)
    s_cmp_gt_u32 s75, 0
    s_cbranch_scc1 L_d36
    s_waitcnt vmcnt(2)
L_d36:
    buffer_load_dwordx4 v[68:71], v1, s[16:19], s34 offen offset:256 nt
    v_dot2_f32_bf16 v29, v116, v16, 0
    v_dot2_f32_bf16 v29, v117, v17, v29
    v_dot2_f32_bf16 v29, v118, v18, v29
    v_dot2_f32_bf16 v29, v119, v19, v29
    v_and_b32 v30, v20, v4
    v_sub_f32 v20, v20, v30
    v_add_f32_dpp v21, v21, v21 quad_perm:[2,3,0,1] row_mask:0xf bank_mask:0xf
    v_add_f32_dpp v22, v22, v22 quad_perm:[1,0,3,2] row_mask:0xf bank_mask:0xf
    v_add_f32_dpp v23, v23, v23 row_half_mirror row_mask:0xf bank_mask:0xf
    v_add_f32_dpp v24, v28, v28 row_ror:8 row_mask:0xf bank_mask:0xc
    s_waitcnt vmcnt(3)
    buffer_load_dwordx4 v[72:75], v1, s[16:19], s34 offen offset:512 nt
    s_add_u32 s38, s46, 28672
    buffer_load_dwordx4 v[156:159], v3, s[24:27], s38 offen offset:0
    v_dot2_f32_bf16 v28, v120, v16, 0
    v_dot2_f32_bf16 v28, v121, v17, v28
    v_dot2_f32_bf16 v28, v122, v18, v28
    v_dot2_f32_bf16 v28, v123, v19, v28
    v_and_b32 v31, v21, v4
    v_sub_f32 v21, v21, v31
    v_add_f32_dpp v22, v22, v22 quad_perm:[2,3,0,1] row_mask:0xf bank_mask:0xf
    v_add_f32_dpp v23, v23, v23 quad_perm:[1,0,3,2] row_mask:0xf bank_mask:0xf
    v_add_f32_dpp v24, v24, v24 row_half_mirror row_mask:0xf bank_mask:0xf
    v_add_f32_dpp v25, v29, v29 row_ror:8 row_mask:0xf bank_mask:0xc
    s_waitcnt vmcnt(5)
    s_cmp_ge_u32 s75, 3
    s_cbranch_scc1 L_d37
    s_waitcnt vmcnt(4)
    s_cmp_gt_u32 s75, 1
    s_cbranch_scc1 L_d37
    s_waitcnt vmcnt(2)
L_d37:
    buffer_load_dwordx4 v[76:79], v1, s[16:19], s34 offen offset:768 nt
    s_cmp_lg_u32 s3, 0
    s_cbranch_scc1 L_a38
    v_readlane_b32 s83, v52, 3
    s_mov_b32 s43, 1
    s_nop 3
    s_and_b32 s83, s83, 0xfff80
    s_atomic_add s43, s[76:77], s83 glc
L_a38:
    v_dot2_f32_bf16 v29, v124, v16, 0
    v_dot2_f32_bf16 v29, v125, v17, v29
    v_dot2_f32_bf16 v29, v126, v18, v29
    v_dot2_f32_bf16 v29, v127, v19, v29
    v_and_b32 v30, v22, v4
    v_sub_f32 v22, v22, v30
    v_add_f32_dpp v23, v23, v23 quad_perm:[2,3,0,1] row_mask:0xf bank_mask:0xf
    v_add_f32_dpp v24, v24, v24 quad_perm:[1,0,3,2] row_mask:0xf bank_mask:0xf
    v_add_f32_dpp v25, v25, v25 row_half_mirror row_mask:0xf bank_mask:0xf
    v_add_f32_dpp v26, v28, v28 row_ror:8 row_mask:0xf bank_mask:0xc
    v_and_b32 v31, v23, v4
    v_sub_f32 v23, v23, v31
    v_add_f32_dpp v24, v24, v24 quad_perm:[2,3,0,1] row_mask:0xf bank_mask:0xf
    v_add_f32_dpp v25, v25, v25 quad_perm:[1,0,3,2] row_mask:0xf bank_mask:0xf
    v_add_f32_dpp v26, v26, v26 row_half_mirror row_mask:0xf bank_mask:0xf
    v_add_f32_dpp v27, v29, v29 row_ror:8 row_mask:0xf bank_mask:0xc
    v_and_b32 v30, v24, v4
    v_sub_f32 v24, v24, v30
    v_add_f32_dpp v25, v25, v25 quad_perm:[2,3,0,1] row_mask:0xf bank_mask:0xf
    v_add_f32_dpp v26, v26, v26 quad_perm:[1,0,3,2] row_mask:0xf bank_mask:0xf
    v_add_f32_dpp v27, v27, v27 row_half_mirror row_mask:0xf bank_mask:0xf
    v_and_b32 v31, v25, v4
    v_sub_f32 v25, v25, v31
    v_add_f32_dpp v26, v26, v26 quad_perm:[2,3,0,1] row_mask:0xf bank_mask:0xf
    v_add_f32_dpp v27, v27, v27 quad_perm:[1,0,3,2] row_mask:0xf bank_mask:0xf
    v_and_b32 v30, v26, v4
    v_sub_f32 v26, v26, v30
    v_add_f32_dpp v27, v27, v27 quad_perm:[2,3,0,1] row_mask:0xf bank_mask:0xf
    v_and_b32 v31, v27, v4
    v_sub_f32 v27, v27, v31
    v_perm_b32 v20, v21, v20, s40
    v_perm_b32 v21, v23, v22, s40
    v_perm_b32 v22, v25, v24, s40
    v_perm_b32 v23, v27, v26, s40
    v_cndmask_b32 v48, v48, v20, s[54:55]
    v_cndmask_b32 v49, v49, v21, s[54:55]
    v_cndmask_b32 v50, v50, v22, s[54:55]
    v_cndmask_b32 v51, v51, v23, s[54:55]
    s_waitcnt vmcnt(11)
    s_nop 0
    v_mfma_f32_16x16x32_bf16 v[224:227], v[192:195], v[48:51], v[224:227]
    v_mfma_f32_16x16x32_bf16 v[228:231], v[196:199], v[48:51], v[228:231]
    v_mfma_f32_16x16x32_bf16 v[232:235], v[200:203], v[48:51], v[232:235]
    v_mfma_f32_16x16x32_bf16 v[236:239], v[204:207], v[48:51], v[236:239]
    v_mfma_f32_16x16x32_bf16 v[240:243], v[208:211], v[48:51], v[240:243]
    v_mfma_f32_16x16x32_bf16 v[244:247], v[212:215], v[48:51], v[244:247]
    v_mfma_f32_16x16x32_bf16 v[248:251], v[216:219], v[48:51], v[248:251]
    v_mfma_f32_16x16x32_bf16 v[252:255], v[220:223], v[48:51], v[252:255]
    s_waitcnt vmcnt(3)
    buffer_load_dwordx4 v[80:83], v1, s[16:19], s34 offen offset:1024 nt
    s_xor_b32 s37, s85, 2048
    buffer_load_dwordx4 v[192:195], v2, s[20:23], s37 offen offset:0
    v_dot2_f32_bf16 v20, v64, v12, 0
    v_dot2_f32_bf16 v20, v65, v13, v20
    v_dot2_f32_bf16 v20, v66, v14, v20
    v_dot2_f32_bf16 v20, v67, v15, v20
    s_waitcnt vmcnt(5)
    s_cmp_ge_u32 s75, 4
    s_cbranch_scc1 L_d39
    s_waitcnt vmcnt(4)
    s_cmp_gt_u32 s75, 0
    s_cbranch_scc1 L_d39
    s_waitcnt vmcnt(2)
L_d39:
    buffer_load_dwordx4 v[84:87], v1, s[16:19], s34 offen offset:1280 nt
    v_dot2_f32_bf16 v21, v68, v12, 0
    v_dot2_f32_bf16 v21, v69, v13, v21
    v_dot2_f32_bf16 v21, v70, v14, v21
    v_dot2_f32_bf16 v21, v71, v15, v21
    v_add_f32_dpp v20, v20, v20 row_ror:8 row_mask:0xf bank_mask:0x3
    s_waitcnt vmcnt(3)
    buffer_load_dwordx4 v[88:91], v1, s[16:19], s34 offen offset:1536 nt
    v_dot2_f32_bf16 v22, v72, v12, 0
    v_dot2_f32_bf16 v22, v73, v13, v22
    v_dot2_f32_bf16 v22, v74, v14, v22
    v_dot2_f32_bf16 v22, v75, v15, v22
    v_add_f32_dpp v21, v21, v21 row_ror:8 row_mask:0xf bank_mask:0x3
    s_waitcnt vmcnt(4)
    s_cmp_ge_u32 s75, 3
    s_cbranch_scc1 L_d40
    s_waitcnt vmcnt(3)
    s_cmp_gt_u32 s75, 1
    s_cbranch_scc1 L_d40
    s_waitcnt vmcnt(1)
L_d40:
    buffer_load_dwordx4 v[92:95], v1, s[16:19], s34 offen offset:1792 nt
    s_xor_b32 s37, s85, 34816
    buffer_load_dwordx4 v[196:199], v2, s[20:23], s37 offen offset:0
    v_dot2_f32_bf16 v23, v76, v12, 0
    v_dot2_f32_bf16 v23, v77, v13, v23
    v_dot2_f32_bf16 v23, v78, v14, v23
    v_dot2_f32_bf16 v23, v79, v15, v23
    v_add_f32_dpp v22, v22, v22 row_ror:8 row_mask:0xf bank_mask:0x3
    s_waitcnt vmcnt(3)
    buffer_load_dwordx4 v[96:99], v1, s[16:19], s35 offen offset:0 nt
    v_dot2_f32_bf16 v24, v80, v12, 0
    v_dot2_f32_bf16 v24, v81, v13, v24
    v_dot2_f32_bf16 v24, v82, v14, v24
    v_dot2_f32_bf16 v24, v83, v15, v24
    v_add_f32_dpp v23, v23, v23 row_ror:8 row_mask:0xf bank_mask:0x3
    s_waitcnt vmcnt(4)
    s_cmp_ge_u32 s75, 4
    s_cbranch_scc1 L_d41
    s_waitcnt vmcnt(3)
    s_cmp_gt_u32 s75, 0
    s_cbranch_scc1 L_d41
    s_waitcnt vmcnt(2)
L_d41:
    buffer_load_dwordx4 v[100:103], v1, s[16:19], s35 offen offset:256 nt
    v_readlane_b32 s82, v53, 3
    s_waitcnt lgkmcnt(0)
    s_sub_u32 s43, s43, s82
    s_min_u32 s43, s43, 3
    s_lshl_b32 s43, s43, 2
    s_lshr_b32 s43, 0x3221, s43
    s_and_b32 s43, s43, 7
    v_mov_b32 v55, s43
    s_cmp_lg_u32 s3, 0
    s_cbranch_scc1 L_w42
    ds_write_b32 v56, v55 offset:11264
L_w42:
    v_dot2_f32_bf16 v25, v84, v12, 0
    v_dot2_f32_bf16 v25, v85, v13, v25
    v_dot2_f32_bf16 v25, v86, v14, v25
    v_dot2_f32_bf16 v25, v87, v15, v25
    v_add_f32_dpp v24, v24, v24 row_ror:8 row_mask:0xf bank_mask:0x3
    s_waitcnt vmcnt(3)
    buffer_load_dwordx4 v[104:107], v1, s[16:19], s35 offen offset:512 nt
    s_xor_b32 s37, s85, 67584
    buffer_load_dwordx4 v[200:203], v2, s[20:23], s37 offen offset:0
    v_dot2_f32_bf16 v26, v88, v12, 0
    v_dot2_f32_bf16 v26, v89, v13, v26
    v_dot2_f32_bf16 v26, v90, v14, v26
    v_dot2_f32_bf16 v26, v91, v15, v26
    v_add_f32_dpp v25, v25, v25 row_ror:8 row_mask:0xf bank_mask:0x3
    s_waitcnt vmcnt(5)
    s_cmp_ge_u32 s75, 3
    s_cbranch_scc1 L_d43
    s_waitcnt vmcnt(3)
    s_cmp_gt_u32 s75, 1
    s_cbranch_scc1 L_d43
    s_waitcnt vmcnt(2)
L_d43:
    buffer_load_dwordx4 v[108:111], v1, s[16:19], s35 offen offset:768 nt
    v_dot2_f32_bf16 v27, v92, v12, 0
    v_dot2_f32_bf16 v27, v93, v13, v27
    v_dot2_f32_bf16 v27, v94, v14, v27
    v_dot2_f32_bf16 v27, v95, v15, v27
    v_add_f32_dpp v26, v26, v26 row_ror:8 row_mask:0xf bank_mask:0x3
    s_waitcnt vmcnt(3)
    buffer_load_dwordx4 v[112:115], v1, s[16:19], s35 offen offset:1024 nt
    ds_read_b32 v55, v56 offset:11264
    v_dot2_f32_bf16 v28, v96, v16, 0
    v_dot2_f32_bf16 v28, v97, v17, v28
    v_dot2_f32_bf16 v28, v98, v18, v28
    v_dot2_f32_bf16 v28, v99, v19, v28
    v_add_f32_dpp v27, v27, v27 row_ror:8 row_mask:0xf bank_mask:0x3
    s_waitcnt vmcnt(4)
    s_cmp_ge_u32 s75, 4
    s_cbranch_scc1 L_d44
    s_waitcnt vmcnt(3)
    s_cmp_gt_u32 s75, 0
    s_cbranch_scc1 L_d44
    s_waitcnt vmcnt(1)
L_d44:
    buffer_load_dwordx4 v[116:119], v1, s[16:19], s35 offen offset:1280 nt
    s_xor_b32 s37, s85, 100352
    buffer_load_dwordx4 v[204:207], v2, s[20:23], s37 offen offset:0
    s_waitcnt lgkmcnt(0)
    v_readfirstlane_b32 s75, v55
    s_nop 0
    v_dot2_f32_bf16 v29, v100, v16, 0
    v_dot2_f32_bf16 v29, v101, v17, v29
    v_dot2_f32_bf16 v29, v102, v18, v29
    v_dot2_f32_bf16 v29, v103, v19, v29
    v_add_f32_dpp v20, v28, v28 row_ror:8 row_mask:0xf bank_mask:0xc
    s_waitcnt vmcnt(3)
    buffer_load_dwordx4 v[120:123], v1, s[16:19], s35 offen offset:1536 nt
    v_dot2_f32_bf16 v28, v104, v16, 0
    v_dot2_f32_bf16 v28, v105, v17, v28
    v_dot2_f32_bf16 v28, v106, v18, v28
    v_dot2_f32_bf16 v28, v107, v19, v28
    v_add_f32_dpp v20, v20, v20 row_half_mirror row_mask:0xf bank_mask:0xf
    v_add_f32_dpp v21, v29, v29 row_ror:8 row_mask:0xf bank_mask:0xc
    s_waitcnt vmcnt(4)
    s_cmp_ge_u32 s75, 3
    s_cbranch_scc1 L_d45
    s_waitcnt vmcnt(3)
    s_cmp_gt_u32 s75, 1
    s_cbranch_scc1 L_d45
    s_waitcnt vmcnt(2)
L_d45:
    buffer_load_dwordx4 v[124:127], v1, s[16:19], s35 offen offset:1792 nt
    v_dot2_f32_bf16 v29, v108, v16, 0
    v_dot2_f32_bf16 v29, v109, v17, v29
    v_dot2_f32_bf16 v29, v110, v18, v29
    v_dot2_f32_bf16 v29, v111, v19, v29
    v_add_f32_dpp v20, v20, v20 quad_perm:[1,0,3,2] row_mask:0xf bank_mask:0xf
    v_add_f32_dpp v21, v21, v21 row_half_mirror row_mask:0xf bank_mask:0xf
    v_add_f32_dpp v22, v28, v28 row_ror:8 row_mask:0xf bank_mask:0xc
    s_waitcnt vmcnt(3)
    s_xor_b32 s52, s33, 262144
    s_add_u32 s53, s52, 0x80000
    buffer_load_dwordx4 v[64:67], v1, s[16:19], s52 offen offset:0 nt
    s_add_u32 s38, s46, 32768
    buffer_load_dwordx4 v[160:163], v3, s[24:27], s38 offen offset:0
    v_dot2_f32_bf16 v28, v112, v16, 0
    v_dot2_f32_bf16 v28, v113, v17, v28
    v_dot2_f32_bf16 v28, v114, v18, v28
    v_dot2_f32_bf16 v28, v115, v19, v28
    v_add_f32_dpp v20, v20, v20 quad_perm:[2,3,0,1] row_mask:0xf bank_mask:0xf
    v_add_f32_dpp v21, v21, v21 quad_perm:[1,0,3,2] row_mask:0xf bank_mask:0xf
    v_add_f32_dpp v22, v22, v22 row_half_mirror row_mask:0xf bank_mask:0xf
    v_add_f32_dpp v23, v29, v29 row_ror:8 row_mask:0xf bank_mask:0xc
    s_waitcnt vmcnt(5)
    s_cmp_ge_u32 s75, 4
    s_cbranch_scc1 L_d46
    s_waitcnt vmcnt(3)
    s_cmp_gt_u32 s75, 0
    s_cbranch_scc1 L_d46
    s_waitcnt vmcnt(2)
L_d46:
    buffer_load_dwordx4 v[68:71], v1, s[16:19], s52 offen offset:256 nt
    v_dot2_f32_bf16 v29, v116, v16, 0
    v_dot2_f32_bf16 v29, v117, v17, v29
    v_dot2_f32_bf16 v29, v118, v18, v29
    v_dot2_f32_bf16 v29, v119, v19, v29
    v_and_b32 v30, v20, v4
    v_sub_f32 v20, v20, v30
    v_add_f32_dpp v21, v21, v21 quad_perm:[2,3,0,1] row_mask:0xf bank_mask:0xf
    v_add_f32_dpp v22, v22, v22 quad_perm:[1,0,3,2] row_mask:0xf bank_mask:0xf
    v_add_f32_dpp v23, v23, v23 row_half_mirror row_mask:0xf bank_mask:0xf
    v_add_f32_dpp v24, v28, v28 row_ror:8 row_mask:0xf bank_mask:0xc
    s_waitcnt vmcnt(3)
    buffer_load_dwordx4 v[72:75], v1, s[16:19], s52 offen offset:512 nt
    s_xor_b32 s37, s85, 133120
    buffer_load_dwordx4 v[208:211], v2, s[20:23], s37 offen offset:0
    v_dot2_f32_bf16 v28, v120, v16, 0
    v_dot2_f32_bf16 v28, v121, v17, v28
    v_dot2_f32_bf16 v28, v122, v18, v28
    v_dot2_f32_bf16 v28, v123, v19, v28
    v_and_b32 v31, v21, v4
    v_sub_f32 v21, v21, v31
    v_add_f32_dpp v22, v22, v22 quad_perm:[2,3,0,1] row_mask:0xf bank_mask:0xf
    v_add_f32_dpp v23, v23, v23 quad_perm:[1,0,3,2] row_mask:0xf bank_mask:0xf
    v_add_f32_dpp v24, v24, v24 row_half_mirror row_mask:0xf bank_mask:0xf
    v_add_f32_dpp v25, v29, v29 row_ror:8 row_mask:0xf bank_mask:0xc
    s_waitcnt vmcnt(5)
    s_cmp_ge_u32 s75, 3
    s_cbranch_scc1 L_d47
    s_waitcnt vmcnt(4)
    s_cmp_gt_u32 s75, 1
    s_cbranch_scc1 L_d47
    s_waitcnt vmcnt(2)
L_d47:
    buffer_load_dwordx4 v[76:79], v1, s[16:19], s52 offen offset:768 nt
    s_cmp_lg_u32 s3, 0
    s_cbranch_scc1 L_a48
    v_readlane_b32 s83, v52, 4
    s_mov_b32 s43, 1
    s_nop 3
    s_and_b32 s83, s83, 0xfff80
    s_atomic_add s43, s[76:77], s83 glc
L_a48:
    v_dot2_f32_bf16 v29, v124, v16, 0
    v_dot2_f32_bf16 v29, v125, v17, v29
    v_dot2_f32_bf16 v29, v126, v18, v29
    v_dot2_f32_bf16 v29, v127, v19, v29
    v_and_b32 v30, v22, v4
    v_sub_f32 v22, v22, v30
    v_add_f32_dpp v23, v23, v23 quad_perm:[2,3,0,1] row_mask:0xf bank_mask:0xf
    v_add_f32_dpp v24, v24, v24 quad_perm:[1,0,3,2] row_mask:0xf bank_mask:0xf
    v_add_f32_dpp v25, v25, v25 row_half_mirror row_mask:0xf bank_mask:0xf
    v_add_f32_dpp v26, v28, v28 row_ror:8 row_mask:0xf bank_mask:0xc
    v_and_b32 v31, v23, v4
    v_sub_f32 v23, v23, v31
    v_add_f32_dpp v24, v24, v24 quad_perm:[2,3,0,1] row_mask:0xf bank_mask:0xf
    v_add_f32_dpp v25, v25, v25 quad_perm:[1,0,3,2] row_mask:0xf bank_mask:0xf
    v_add_f32_dpp v26, v26, v26 row_half_mirror row_mask:0xf bank_mask:0xf
    v_add_f32_dpp v27, v29, v29 row_ror:8 row_mask:0xf bank_mask:0xc
    v_and_b32 v30, v24, v4
    v_sub_f32 v24, v24, v30
    v_add_f32_dpp v25, v25, v25 quad_perm:[2,3,0,1] row_mask:0xf bank_mask:0xf
    v_add_f32_dpp v26, v26, v26 quad_perm:[1,0,3,2] row_mask:0xf bank_mask:0xf
    v_add_f32_dpp v27, v27, v27 row_half_mirror row_mask:0xf bank_mask:0xf
    v_and_b32 v31, v25, v4
    v_sub_f32 v25, v25, v31
    v_add_f32_dpp v26, v26, v26 quad_perm:[2,3,0,1] row_mask:0xf bank_mask:0xf
    v_add_f32_dpp v27, v27, v27 quad_perm:[1,0,3,2] row_mask:0xf bank_mask:0xf
    v_and_b32 v30, v26, v4
    v_sub_f32 v26, v26, v30
    v_add_f32_dpp v27, v27, v27 quad_perm:[2,3,0,1] row_mask:0xf bank_mask:0xf
    v_and_b32 v31, v27, v4
    v_sub_f32 v27, v27, v31
    v_perm_b32 v48, v21, v20, s40
    v_perm_b32 v49, v23, v22, s40
    v_perm_b32 v50, v25, v24, s40
    v_perm_b32 v51, v27, v26, s40
    s_waitcnt vmcnt(3)
    buffer_load_dwordx4 v[80:83], v1, s[16:19], s52 offen offset:1024 nt
    v_dot2_f32_bf16 v20, v64, v12, 0
    v_dot2_f32_bf16 v20, v65, v13, v20
    v_dot2_f32_bf16 v20, v66, v14, v20
    v_dot2_f32_bf16 v20, v67, v15, v20
    s_waitcnt vmcnt(4)
    s_cmp_ge_u32 s75, 4
    s_cbranch_scc1 L_d49
    s_waitcnt vmcnt(3)
    s_cmp_gt_u32 s75, 0
    s_cbranch_scc1 L_d49
    s_waitcnt vmcnt(1)
L_d49:
    buffer_load_dwordx4 v[84:87], v1, s[16:19], s52 offen offset:1280 nt
    s_xor_b32 s37, s85, 165888
    buffer_load_dwordx4 v[212:215], v2, s[20:23], s37 offen offset:0
    v_dot2_f32_bf16 v21, v68, v12, 0
    v_dot2_f32_bf16 v21, v69, v13, v21
    v_dot2_f32_bf16 v21, v70, v14, v21
    v_dot2_f32_bf16 v21, v71, v15, v21
    v_add_f32_dpp v20, v20, v20 row_ror:8 row_mask:0xf bank_mask:0x3
    s_waitcnt vmcnt(3)
    buffer_load_dwordx4 v[88:91], v1, s[16:19], s52 offen offset:1536 nt
    v_dot2_f32_bf16 v22, v72, v12, 0
    v_dot2_f32_bf16 v22, v73, v13, v22
    v_dot2_f32_bf16 v22, v74, v14, v22
    v_dot2_f32_bf16 v22, v75, v15, v22
    v_add_f32_dpp v21, v21, v21 row_ror:8 row_mask:0xf bank_mask:0x3
    s_waitcnt vmcnt(4)
    s_cmp_ge_u32 s75, 3
    s_cbranch_scc1 L_d50
    s_waitcnt vmcnt(3)
    s_cmp_gt_u32 s75, 1
    s_cbranch_scc1 L_d50
    s_waitcnt vmcnt(2)
L_d50:
    buffer_load_dwordx4 v[92:95], v1, s[16:19], s52 offen offset:1792 nt
    v_dot2_f32_bf16 v23, v76, v12, 0
    v_dot2_f32_bf16 v23, v77, v13, v23
    v_dot2_f32_bf16 v23, v78, v14, v23
    v_dot2_f32_bf16 v23, v79, v15, v23
    v_add_f32_dpp v22, v22, v22 row_ror:8 row_mask:0xf bank_mask:0x3
    s_waitcnt vmcnt(3)
    buffer_load_dwordx4 v[96:99], v1, s[16:19], s53 offen offset:0 nt
    s_xor_b32 s37, s85, 198656
    buffer_load_dwordx4 v[216:219], v2, s[20:23], s37 offen offset:0
    v_dot2_f32_bf16 v24, v80, v12, 0
    v_dot2_f32_bf16 v24, v81, v13, v24
    v_dot2_f32_bf16 v24, v82, v14, v24
    v_dot2_f32_bf16 v24, v83, v15, v24
    v_add_f32_dpp v23, v23, v23 row_ror:8 row_mask:0xf bank_mask:0x3
    s_waitcnt vmcnt(5)
    s_cmp_ge_u32 s75, 4
    s_cbranch_scc1 L_d51
    s_waitcnt vmcnt(3)
    s_cmp_gt_u32 s75, 0
    s_cbranch_scc1 L_d51
    s_waitcnt vmcnt(2)
L_d51:
    buffer_load_dwordx4 v[100:103], v1, s[16:19], s53 offen offset:256 nt
    v_readlane_b32 s82, v53, 4
    s_waitcnt lgkmcnt(0)
    s_sub_u32 s43, s43, s82
    s_min_u32 s43, s43, 3
    s_lshl_b32 s43, s43, 2
    s_lshr_b32 s43, 0x3221, s43
    s_and_b32 s43, s43, 7
    v_mov_b32 v55, s43
    s_cmp_lg_u32 s3, 0
    s_cbranch_scc1 L_w52
    ds_write_b32 v56, v55 offset:11264
L_w52:
    v_dot2_f32_bf16 v25, v84, v12, 0
    v_dot2_f32_bf16 v25, v85, v13, v25
    v_dot2_f32_bf16 v25, v86, v14, v25
    v_dot2_f32_bf16 v25, v87, v15, v25
    v_add_f32_dpp v24, v24, v24 row_ror:8 row_mask:0xf bank_mask:0x3
    s_waitcnt vmcnt(3)
    buffer_load_dwordx4 v[104:107], v1, s[16:19], s53 offen offset:512 nt
    v_dot2_f32_bf16 v26, v88, v12, 0
    v_dot2_f32_bf16 v26, v89, v13, v26
    v_dot2_f32_bf16 v26, v90, v14, v26
    v_dot2_f32_bf16 v26, v91, v15, v26
    v_add_f32_dpp v25, v25, v25 row_ror:8 row_mask:0xf bank_mask:0x3
    s_waitcnt vmcnt(4)
    s_cmp_ge_u32 s75, 3
    s_cbranch_scc1 L_d53
    s_waitcnt vmcnt(3)
    s_cmp_gt_u32 s75, 1
    s_cbranch_scc1 L_d53
    s_waitcnt vmcnt(1)
L_d53:
    buffer_load_dwordx4 v[108:111], v1, s[16:19], s53 offen offset:768 nt
    s_xor_b32 s37, s85, 231424
    buffer_load_dwordx4 v[220:223], v2, s[20:23], s37 offen offset:0
    v_dot2_f32_bf16 v27, v92, v12, 0
    v_dot2_f32_bf16 v27, v93, v13, v27
    v_dot2_f32_bf16 v27, v94, v14, v27
    v_dot2_f32_bf16 v27, v95, v15, v27
    v_add_f32_dpp v26, v26, v26 row_ror:8 row_mask:0xf bank_mask:0x3
    s_waitcnt vmcnt(3)
    buffer_load_dwordx4 v[112:115], v1, s[16:19], s53 offen offset:1024 nt
    ds_read_b32 v55, v56 offset:11264
    v_dot2_f32_bf16 v28, v96, v16, 0
    v_dot2_f32_bf16 v28, v97, v17, v28
    v_dot2_f32_bf16 v28, v98, v18, v28
    v_dot2_f32_bf16 v28, v99, v19, v28
    v_add_f32_dpp v27, v27, v27 row_ror:8 row_mask:0xf bank_mask:0x3
    s_waitcnt vmcnt(4)
    s_cmp_ge_u32 s75, 4
    s_cbranch_scc1 L_d54
    s_waitcnt vmcnt(3)
    s_cmp_gt_u32 s75, 0
    s_cbranch_scc1 L_d54
    s_waitcnt vmcnt(2)
L_d54:
    buffer_load_dwordx4 v[116:119], v1, s[16:19], s53 offen offset:1280 nt
    s_waitcnt lgkmcnt(0)
    v_readfirstlane_b32 s75, v55
    s_nop 0
    v_dot2_f32_bf16 v29, v100, v16, 0
    v_dot2_f32_bf16 v29, v101, v17, v29
    v_dot2_f32_bf16 v29, v102, v18, v29
    v_dot2_f32_bf16 v29, v103, v19, v29
    v_add_f32_dpp v20, v28, v28 row_ror:8 row_mask:0xf bank_mask:0xc
    s_waitcnt vmcnt(3)
    buffer_load_dwordx4 v[120:123], v1, s[16:19], s53 offen offset:1536 nt
    s_add_u32 s38, s46, 36864
    buffer_load_dwordx4 v[164:167], v3, s[24:27], s38 offen offset:0
    v_dot2_f32_bf16 v28, v104, v16, 0
    v_dot2_f32_bf16 v28, v105, v17, v28
    v_dot2_f32_bf16 v28, v106, v18, v28
    v_dot2_f32_bf16 v28, v107, v19, v28
    v_add_f32_dpp v20, v20, v20 row_half_mirror row_mask:0xf bank_mask:0xf
    v_add_f32_dpp v21, v29, v29 row_ror:8 row_mask:0xf bank_mask:0xc
    s_waitcnt vmcnt(5)
    s_cmp_ge_u32 s75, 3
    s_cbranch_scc1 L_d55
    s_waitcnt vmcnt(3)
    s_cmp_gt_u32 s75, 1
    s_cbranch_scc1 L_d55
    s_waitcnt vmcnt(2)
L_d55:
    buffer_load_dwordx4 v[124:127], v1, s[16:19], s53 offen offset:1792 nt
    v_dot2_f32_bf16 v29, v108, v16, 0
    v_dot2_f32_bf16 v29, v109, v17, v29
    v_dot2_f32_bf16 v29, v110, v18, v29
    v_dot2_f32_bf16 v29, v111, v19, v29
    v_add_f32_dpp v20, v20, v20 quad_perm:[1,0,3,2] row_mask:0xf bank_mask:0xf
    v_add_f32_dpp v21, v21, v21 row_half_mirror row_mask:0xf bank_mask:0xf
    v_add_f32_dpp v22, v28, v28 row_ror:8 row_mask:0xf bank_mask:0xc
    s_waitcnt vmcnt(3)
    s_xor_b32 s34, s32, 393216
    s_add_u32 s35, s34, 0x80000
    buffer_load_dwordx4 v[64:67], v1, s[16:19], s34 offen offset:0 nt
    s_add_u32 s38, s46, 40960
    buffer_load_dwordx4 v[168:171], v3, s[24:27], s38 offen offset:0
    v_dot2_f32_bf16 v28, v112, v16, 0
    v_dot2_f32_bf16 v28, v113, v17, v28
    v_dot2_f32_bf16 v28, v114, v18, v28
    v_dot2_f32_bf16 v28, v115, v19, v28
    v_add_f32_dpp v20, v20, v20 quad_perm:[2,3,0,1] row_mask:0xf bank_mask:0xf
    v_add_f32_dpp v21, v21, v21 quad_perm:[1,0,3,2] row_mask:0xf bank_mask:0xf
    v_add_f32_dpp v22, v22, v22 row_half_mirror row_mask:0xf bank_mask:0xf
    v_add_f32_dpp v23, v29, v29 row_ror:8 row_mask:0xf bank_mask:0xc
    s_waitcnt vmcnt(5)
    s_cmp_ge_u32 s75, 4
    s_cbranch_scc1 L_d56
    s_waitcnt vmcnt(4)
    s_cmp_gt_u32 s75, 0
    s_cbranch_scc1 L_d56
    s_waitcnt vmcnt(2)
L_d56:
    buffer_load_dwordx4 v[68:71], v1, s[16:19], s34 offen offset:256 nt
    v_dot2_f32_bf16 v29, v116, v16, 0
    v_dot2_f32_bf16 v29, v117, v17, v29
    v_dot2_f32_bf16 v29, v118, v18, v29
    v_dot2_f32_bf16 v29, v119, v19, v29
    v_and_b32 v30, v20, v4
    v_sub_f32 v20, v20, v30
    v_add_f32_dpp v21, v21, v21 quad_perm:[2,3,0,1] row_mask:0xf bank_mask:0xf
    v_add_f32_dpp v22, v22, v22 quad_perm:[1,0,3,2] row_mask:0xf bank_mask:0xf
    v_add_f32_dpp v23, v23, v23 row_half_mirror row_mask:0xf bank_mask:0xf
    v_add_f32_dpp v24, v28, v28 row_ror:8 row_mask:0xf bank_mask:0xc
    s_waitcnt vmcnt(3)
    buffer_load_dwordx4 v[72:75], v1, s[16:19], s34 offen offset:512 nt
    s_add_u32 s38, s46, 45056
    buffer_load_dwordx4 v[172:175], v3, s[24:27], s38 offen offset:0
    v_dot2_f32_bf16 v28, v120, v16, 0
    v_dot2_f32_bf16 v28, v121, v17, v28
    v_dot2_f32_bf16 v28, v122, v18, v28
    v_dot2_f32_bf16 v28, v123, v19, v28
    v_and_b32 v31, v21, v4
    v_sub_f32 v21, v21, v31
    v_add_f32_dpp v22, v22, v22 quad_perm:[2,3,0,1] row_mask:0xf bank_mask:0xf
    v_add_f32_dpp v23, v23, v23 quad_perm:[1,0,3,2] row_mask:0xf bank_mask:0xf
    v_add_f32_dpp v24, v24, v24 row_half_mirror row_mask:0xf bank_mask:0xf
    v_add_f32_dpp v25, v29, v29 row_ror:8 row_mask:0xf bank_mask:0xc
    s_waitcnt vmcnt(5)
    s_cmp_ge_u32 s75, 3
    s_cbranch_scc1 L_d57
    s_waitcnt vmcnt(4)
    s_cmp_gt_u32 s75, 1
    s_cbranch_scc1 L_d57
    s_waitcnt vmcnt(2)
L_d57:
    buffer_load_dwordx4 v[76:79], v1, s[16:19], s34 offen offset:768 nt
    s_cmp_lg_u32 s3, 0
    s_cbranch_scc1 L_a58
    v_readlane_b32 s83, v52, 5
    s_mov_b32 s43, 1
    s_nop 3
    s_and_b32 s83, s83, 0xfff80
    s_atomic_add s43, s[76:77], s83 glc
L_a58:
    v_dot2_f32_bf16 v29, v124, v16, 0
    v_dot2_f32_bf16 v29, v125, v17, v29
    v_dot2_f32_bf16 v29, v126, v18, v29
    v_dot2_f32_bf16 v29, v127, v19, v29
    v_and_b32 v30, v22, v4
    v_sub_f32 v22, v22, v30
    v_add_f32_dpp v23, v23, v23 quad_perm:[2,3,0,1] row_mask:0xf bank_mask:0xf
    v_add_f32_dpp v24, v24, v24 quad_perm:[1,0,3,2] row_mask:0xf bank_mask:0xf
    v_add_f32_dpp v25, v25, v25 row_half_mirror row_mask:0xf bank_mask:0xf
    v_add_f32_dpp v26, v28, v28 row_ror:8 row_mask:0xf bank_mask:0xc
    v_and_b32 v31, v23, v4
    v_sub_f32 v23, v23, v31
    v_add_f32_dpp v24, v24, v24 quad_perm:[2,3,0,1] row_mask:0xf bank_mask:0xf
    v_add_f32_dpp v25, v25, v25 quad_perm:[1,0,3,2] row_mask:0xf bank_mask:0xf
    v_add_f32_dpp v26, v26, v26 row_half_mirror row_mask:0xf bank_mask:0xf
    v_add_f32_dpp v27, v29, v29 row_ror:8 row_mask:0xf bank_mask:0xc
    v_and_b32 v30, v24, v4
    v_sub_f32 v24, v24, v30
    v_add_f32_dpp v25, v25, v25 quad_perm:[2,3,0,1] row_mask:0xf bank_mask:0xf
    v_add_f32_dpp v26, v26, v26 quad_perm:[1,0,3,2] row_mask:0xf bank_mask:0xf
    v_add_f32_dpp v27, v27, v27 row_half_mirror row_mask:0xf bank_mask:0xf
    v_and_b32 v31, v25, v4
    v_sub_f32 v25, v25, v31
    v_add_f32_dpp v26, v26, v26 quad_perm:[2,3,0,1] row_mask:0xf bank_mask:0xf
    v_add_f32_dpp v27, v27, v27 quad_perm:[1,0,3,2] row_mask:0xf bank_mask:0xf
    v_and_b32 v30, v26, v4
    v_sub_f32 v26, v26, v30
    v_add_f32_dpp v27, v27, v27 quad_perm:[2,3,0,1] row_mask:0xf bank_mask:0xf
    v_and_b32 v31, v27, v4
    v_sub_f32 v27, v27, v31
    v_perm_b32 v20, v21, v20, s40
    v_perm_b32 v21, v23, v22, s40
    v_perm_b32 v22, v25, v24, s40
    v_perm_b32 v23, v27, v26, s40
    v_cndmask_b32 v48, v48, v20, s[54:55]
    v_cndmask_b32 v49, v49, v21, s[54:55]
    v_cndmask_b32 v50, v50, v22, s[54:55]
    v_cndmask_b32 v51, v51, v23, s[54:55]
    s_waitcnt vmcnt(11)
    s_nop 0
    v_mfma_f32_16x16x32_bf16 v[224:227], v[192:195], v[48:51], v[224:227]
    v_mfma_f32_16x16x32_bf16 v[228:231], v[196:199], v[48:51], v[228:231]
    v_mfma_f32_16x16x32_bf16 v[232:235], v[200:203], v[48:51], v[232:235]
    v_mfma_f32_16x16x32_bf16 v[236:239], v[204:207], v[48:51], v[236:239]
    v_mfma_f32_16x16x32_bf16 v[240:243], v[208:211], v[48:51], v[240:243]
    v_mfma_f32_16x16x32_bf16 v[244:247], v[212:215], v[48:51], v[244:247]
    v_mfma_f32_16x16x32_bf16 v[248:251], v[216:219], v[48:51], v[248:251]
    v_mfma_f32_16x16x32_bf16 v[252:255], v[220:223], v[48:51], v[252:255]
    s_waitcnt vmcnt(3)
    buffer_load_dwordx4 v[80:83], v1, s[16:19], s34 offen offset:1024 nt
    s_xor_b32 s37, s85, 3072
    buffer_load_dwordx4 v[192:195], v2, s[20:23], s37 offen offset:0
    v_dot2_f32_bf16 v20, v64, v12, 0
    v_dot2_f32_bf16 v20, v65, v13, v20
    v_dot2_f32_bf16 v20, v66, v14, v20
    v_dot2_f32_bf16 v20, v67, v15, v20
    s_waitcnt vmcnt(5)
    s_cmp_ge_u32 s75, 4
    s_cbranch_scc1 L_d59
    s_waitcnt vmcnt(4)
    s_cmp_gt_u32 s75, 0
    s_cbranch_scc1 L_d59
    s_waitcnt vmcnt(2)
L_d59:
    buffer_load_dwordx4 v[84:87], v1, s[16:19], s34 offen offset:1280 nt
    s_add_u32 s38, s46, 49152
    buffer_load_dwordx4 v[176:179], v3, s[24:27], s38 offen offset:0
    v_dot2_f32_bf16 v21, v68, v12, 0
    v_dot2_f32_bf16 v21, v69, v13, v21
    v_dot2_f32_bf16 v21, v70, v14, v21
    v_dot2_f32_bf16 v21, v71, v15, v21
    v_add_f32_dpp v20, v20, v20 row_ror:8 row_mask:0xf bank_mask:0x3
    s_waitcnt vmcnt(4)
    buffer_load_dwordx4 v[88:91], v1, s[16:19], s34 offen offset:1536 nt
    v_dot2_f32_bf16 v22, v72, v12, 0
    v_dot2_f32_bf16 v22, v73, v13, v22
    v_dot2_f32_bf16 v22, v74, v14, v22
    v_dot2_f32_bf16 v22, v75, v15, v22
    v_add_f32_dpp v21, v21, v21 row_ror:8 row_mask:0xf bank_mask:0x3
    s_waitcnt vmcnt(5)
    s_cmp_ge_u32 s75, 3
    s_cbranch_scc1 L_d60
    s_waitcnt vmcnt(4)
    s_cmp_gt_u32 s75, 1
    s_cbranch_scc1 L_d60
    s_waitcnt vmcnt(2)
L_d60:
    buffer_load_dwordx4 v[92:95], v1, s[16:19], s34 offen offset:1792 nt
    s_xor_b32 s37, s85, 35840
    buffer_load_dwordx4 v[196:199], v2, s[20:23], s37 offen offset:0
    v_dot2_f32_bf16 v23, v76, v12, 0
    v_dot2_f32_bf16 v23, v77, v13, v23
    v_dot2_f32_bf16 v23, v78, v14, v23
    v_dot2_f32_bf16 v23, v79, v15, v23
    v_add_f32_dpp v22, v22, v22 row_ror:8 row_mask:0xf bank_mask:0x3
    s_waitcnt vmcnt(4)
    buffer_load_dwordx4 v[96:99], v1, s[16:19], s35 offen offset:0 nt
    s_add_u32 s38, s46, 53248
    buffer_load_dwordx4 v[180:183], v3, s[24:27], s38 offen offset:0
    v_dot2_f32_bf16 v24, v80, v12, 0
    v_dot2_f32_bf16 v24, v81, v13, v24
    v_dot2_f32_bf16 v24, v82, v14, v24
    v_dot2_f32_bf16 v24, v83, v15, v24
    v_add_f32_dpp v23, v23, v23 row_ror:8 row_mask:0xf bank_mask:0x3
    s_waitcnt vmcnt(6)
    s_cmp_ge_u32 s75, 4
    s_cbranch_scc1 L_d61
    s_waitcnt vmcnt(4)
    s_cmp_gt_u32 s75, 0
    s_cbranch_scc1 L_d61
    s_waitcnt vmcnt(3)
L_d61:
    buffer_load_dwordx4 v[100:103], v1, s[16:19], s35 offen offset:256 nt
    v_readlane_b32 s82, v53, 5
    s_waitcnt lgkmcnt(0)
    s_sub_u32 s43, s43, s82
    s_min_u32 s43, s43, 3
    s_lshl_b32 s43, s43, 2
    s_lshr_b32 s43, 0x3221, s43
    s_and_b32 s43, s43, 7
    v_mov_b32 v55, s43
    s_cmp_lg_u32 s3, 0
    s_cbranch_scc1 L_w62
    ds_write_b32 v56, v55 offset:11264
L_w62:
    v_dot2_f32_bf16 v25, v84, v12, 0
    v_dot2_f32_bf16 v25, v85, v13, v25
    v_dot2_f32_bf16 v25, v86, v14, v25
    v_dot2_f32_bf16 v25, v87, v15, v25
    v_add_f32_dpp v24, v24, v24 row_ror:8 row_mask:0xf bank_mask:0x3
    s_waitcnt vmcnt(4)
    buffer_load_dwordx4 v[104:107], v1, s[16:19], s35 offen offset:512 nt
    s_xor_b32 s37, s85, 68608
    buffer_load_dwordx4 v[200:203], v2, s[20:23], s37 offen offset:0
    v_dot2_f32_bf16 v26, v88, v12, 0
    v_dot2_f32_bf16 v26, v89, v13, v26
    v_dot2_f32_bf16 v26, v90, v14, v26
    v_dot2_f32_bf16 v26, v91, v15, v26
    v_add_f32_dpp v25, v25, v25 row_ror:8 row_mask:0xf bank_mask:0x3
    s_waitcnt vmcnt(6)
    s_cmp_ge_u32 s75, 3
    s_cbranch_scc1 L_d63
    s_waitcnt vmcnt(4)
    s_cmp_gt_u32 s75, 1
    s_cbranch_scc1 L_d63
    s_waitcnt vmcnt(2)
L_d63:
    buffer_load_dwordx4 v[108:111], v1, s[16:19], s35 offen offset:768 nt
    v_dot2_f32_bf16 v27, v92, v12, 0
    v_dot2_f32_bf16 v27, v93, v13, v27
    v_dot2_f32_bf16 v27, v94, v14, v27
    v_dot2_f32_bf16 v27, v95, v15, v27
    v_add_f32_dpp v26, v26, v26 row_ror:8 row_mask:0xf bank_mask:0x3
    s_waitcnt vmcnt(3)
    buffer_load_dwordx4 v[112:115], v1, s[16:19], s35 offen offset:1024 nt
    ds_read_b32 v55, v56 offset:11264
    v_dot2_f32_bf16 v28, v96, v16, 0
    v_dot2_f32_bf16 v28, v97, v17, v28
    v_dot2_f32_bf16 v28, v98, v18, v28
    v_dot2_f32_bf16 v28, v99, v19, v28
    v_add_f32_dpp v27, v27, v27 row_ror:8 row_mask:0xf bank_mask:0x3
    s_waitcnt vmcnt(4)
    s_cmp_ge_u32 s75, 4
    s_cbranch_scc1 L_d64
    s_waitcnt vmcnt(3)
    s_cmp_gt_u32 s75, 0
    s_cbranch_scc1 L_d64
    s_waitcnt vmcnt(1)
L_d64:
    buffer_load_dwordx4 v[116:119], v1, s[16:19], s35 offen offset:1280 nt
    s_xor_b32 s37, s85, 101376
    buffer_load_dwordx4 v[204:207], v2, s[20:23], s37 offen offset:0
    s_waitcnt lgkmcnt(0)
    v_readfirstlane_b32 s75, v55
    s_nop 0
    v_dot2_f32_bf16 v29, v100, v16, 0
    v_dot2_f32_bf16 v29, v101, v17, v29
    v_dot2_f32_bf16 v29, v102, v18, v29
    v_dot2_f32_bf16 v29, v103, v19, v29
    v_add_f32_dpp v20, v28, v28 row_ror:8 row_mask:0xf bank_mask:0xc
    s_waitcnt vmcnt(3)
    buffer_load_dwordx4 v[120:123], v1, s[16:19], s35 offen offset:1536 nt
    v_dot2_f32_bf16 v28, v104, v16, 0
    v_dot2_f32_bf16 v28, v105, v17, v28
    v_dot2_f32_bf16 v28, v106, v18, v28
    v_dot2_f32_bf16 v28, v107, v19, v28
    v_add_f32_dpp v20, v20, v20 row_half_mirror row_mask:0xf bank_mask:0xf
    v_add_f32_dpp v21, v29, v29 row_ror:8 row_mask:0xf bank_mask:0xc
    s_waitcnt vmcnt(4)
    s_cmp_ge_u32 s75, 3
    s_cbranch_scc1 L_d65
    s_waitcnt vmcnt(3)
    s_cmp_gt_u32 s75, 1
    s_cbranch_scc1 L_d65
    s_waitcnt vmcnt(2)
L_d65:
    buffer_load_dwordx4 v[124:127], v1, s[16:19], s35 offen offset:1792 nt
    v_dot2_f32_bf16 v29, v108, v16, 0
    v_dot2_f32_bf16 v29, v109, v17, v29
    v_dot2_f32_bf16 v29, v110, v18, v29
    v_dot2_f32_bf16 v29, v111, v19, v29
    v_add_f32_dpp v20, v20, v20 quad_perm:[1,0,3,2] row_mask:0xf bank_mask:0xf
    v_add_f32_dpp v21, v21, v21 row_half_mirror row_mask:0xf bank_mask:0xf
    v_add_f32_dpp v22, v28, v28 row_ror:8 row_mask:0xf bank_mask:0xc
    s_waitcnt vmcnt(3)
    s_xor_b32 s52, s33, 393216
    s_add_u32 s53, s52, 0x80000
    buffer_load_dwordx4 v[64:67], v1, s[16:19], s52 offen offset:0 nt
    s_add_u32 s38, s46, 57344
    buffer_load_dwordx4 v[184:187], v3, s[24:27], s38 offen offset:0
    v_dot2_f32_bf16 v28, v112, v16, 0
    v_dot2_f32_bf16 v28, v113, v17, v28
    v_dot2_f32_bf16 v28, v114, v18, v28
    v_dot2_f32_bf16 v28, v115, v19, v28
    v_add_f32_dpp v20, v20, v20 quad_perm:[2,3,0,1] row_mask:0xf bank_mask:0xf
    v_add_f32_dpp v21, v21, v21 quad_perm:[1,0,3,2] row_mask:0xf bank_mask:0xf
    v_add_f32_dpp v22, v22, v22 row_half_mirror row_mask:0xf bank_mask:0xf
    v_add_f32_dpp v23, v29, v29 row_ror:8 row_mask:0xf bank_mask:0xc
    s_waitcnt vmcnt(5)
    s_cmp_ge_u32 s75, 4
    s_cbranch_scc1 L_d66
    s_waitcnt vmcnt(3)
    s_cmp_gt_u32 s75, 0
    s_cbranch_scc1 L_d66
    s_waitcnt vmcnt(2)
L_d66:
    buffer_load_dwordx4 v[68:71], v1, s[16:19], s52 offen offset:256 nt
    v_dot2_f32_bf16 v29, v116, v16, 0
    v_dot2_f32_bf16 v29, v117, v17, v29
    v_dot2_f32_bf16 v29, v118, v18, v29
    v_dot2_f32_bf16 v29, v119, v19, v29
    v_and_b32 v30, v20, v4
    v_sub_f32 v20, v20, v30
    v_add_f32_dpp v21, v21, v21 quad_perm:[2,3,0,1] row_mask:0xf bank_mask:0xf
    v_add_f32_dpp v22, v22, v22 quad_perm:[1,0,3,2] row_mask:0xf bank_mask:0xf
    v_add_f32_dpp v23, v23, v23 row_half_mirror row_mask:0xf bank_mask:0xf
    v_add_f32_dpp v24, v28, v28 row_ror:8 row_mask:0xf bank_mask:0xc
    s_waitcnt vmcnt(3)
    buffer_load_dwordx4 v[72:75], v1, s[16:19], s52 offen offset:512 nt
    s_xor_b32 s37, s85, 134144
    buffer_load_dwordx4 v[208:211], v2, s[20:23], s37 offen offset:0
    v_dot2_f32_bf16 v28, v120, v16, 0
    v_dot2_f32_bf16 v28, v121, v17, v28
    v_dot2_f32_bf16 v28, v122, v18, v28
    v_dot2_f32_bf16 v28, v123, v19, v28
    v_and_b32 v31, v21, v4
    v_sub_f32 v21, v21, v31
    v_add_f32_dpp v22, v22, v22 quad_perm:[2,3,0,1] row_mask:0xf bank_mask:0xf
    v_add_f32_dpp v23, v23, v23 quad_perm:[1,0,3,2] row_mask:0xf bank_mask:0xf
    v_add_f32_dpp v24, v24, v24 row_half_mirror row_mask:0xf bank_mask:0xf
    v_add_f32_dpp v25, v29, v29 row_ror:8 row_mask:0xf bank_mask:0xc
    s_waitcnt vmcnt(5)
    s_cmp_ge_u32 s75, 3
    s_cbranch_scc1 L_d67
    s_waitcnt vmcnt(4)
    s_cmp_gt_u32 s75, 1
    s_cbranch_scc1 L_d67
    s_waitcnt vmcnt(2)
L_d67:
    buffer_load_dwordx4 v[76:79], v1, s[16:19], s52 offen offset:768 nt
    s_add_u32 s38, s46, 61440
    buffer_load_dwordx4 v[188:191], v3, s[24:27], s38 offen offset:0
    s_cmp_lg_u32 s3, 0
    s_cbranch_scc1 L_a68
    v_readlane_b32 s83, v52, 6
    s_mov_b32 s43, 1
    s_nop 3
    s_and_b32 s83, s83, 0xfff80
    s_atomic_add s43, s[76:77], s83 glc
L_a68:
    v_dot2_f32_bf16 v29, v124, v16, 0
    v_dot2_f32_bf16 v29, v125, v17, v29
    v_dot2_f32_bf16 v29, v126, v18, v29
    v_dot2_f32_bf16 v29, v127, v19, v29
    v_and_b32 v30, v22, v4
    v_sub_f32 v22, v22, v30
    v_add_f32_dpp v23, v23, v23 quad_perm:[2,3,0,1] row_mask:0xf bank_mask:0xf
    v_add_f32_dpp v24, v24, v24 quad_perm:[1,0,3,2] row_mask:0xf bank_mask:0xf
    v_add_f32_dpp v25, v25, v25 row_half_mirror row_mask:0xf bank_mask:0xf
    v_add_f32_dpp v26, v28, v28 row_ror:8 row_mask:0xf bank_mask:0xc
    v_and_b32 v31, v23, v4
    v_sub_f32 v23, v23, v31
    v_add_f32_dpp v24, v24, v24 quad_perm:[2,3,0,1] row_mask:0xf bank_mask:0xf
    v_add_f32_dpp v25, v25, v25 quad_perm:[1,0,3,2] row_mask:0xf bank_mask:0xf
    v_add_f32_dpp v26, v26, v26 row_half_mirror row_mask:0xf bank_mask:0xf
    v_add_f32_dpp v27, v29, v29 row_ror:8 row_mask:0xf bank_mask:0xc
    v_and_b32 v30, v24, v4
    v_sub_f32 v24, v24, v30
    v_add_f32_dpp v25, v25, v25 quad_perm:[2,3,0,1] row_mask:0xf bank_mask:0xf
    v_add_f32_dpp v26, v26, v26 quad_perm:[1,0,3,2] row_mask:0xf bank_mask:0xf
    v_add_f32_dpp v27, v27, v27 row_half_mirror row_mask:0xf bank_mask:0xf
    v_and_b32 v31, v25, v4
    v_sub_f32 v25, v25, v31
    v_add_f32_dpp v26, v26, v26 quad_perm:[2,3,0,1] row_mask:0xf bank_mask:0xf
    v_add_f32_dpp v27, v27, v27 quad_perm:[1,0,3,2] row_mask:0xf bank_mask:0xf
    v_and_b32 v30, v26, v4
    v_sub_f32 v26, v26, v30
    v_add_f32_dpp v27, v27, v27 quad_perm:[2,3,0,1] row_mask:0xf bank_mask:0xf
    v_and_b32 v31, v27, v4
    v_sub_f32 v27, v27, v31
    v_perm_b32 v48, v21, v20, s40
    v_perm_b32 v49, v23, v22, s40
    v_perm_b32 v50, v25, v24, s40
    v_perm_b32 v51, v27, v26, s40
    s_waitcnt vmcnt(4)
    buffer_load_dwordx4 v[80:83], v1, s[16:19], s52 offen offset:1024 nt
    v_dot2_f32_bf16 v20, v64, v12, 0
    v_dot2_f32_bf16 v20, v65, v13, v20
    v_dot2_f32_bf16 v20, v66, v14, v20
    v_dot2_f32_bf16 v20, v67, v15, v20
    s_waitcnt vmcnt(5)
    s_cmp_ge_u32 s75, 4
    s_cbranch_scc1 L_d69
    s_waitcnt vmcnt(4)
    s_cmp_gt_u32 s75, 0
    s_cbranch_scc1 L_d69
    s_waitcnt vmcnt(2)
L_d69:
    buffer_load_dwordx4 v[84:87], v1, s[16:19], s52 offen offset:1280 nt
    s_xor_b32 s37, s85, 166912
    buffer_load_dwordx4 v[212:215], v2, s[20:23], s37 offen offset:0
    v_dot2_f32_bf16 v21, v68, v12, 0
    v_dot2_f32_bf16 v21, v69, v13, v21
    v_dot2_f32_bf16 v21, v70, v14, v21
    v_dot2_f32_bf16 v21, v71, v15, v21
    v_add_f32_dpp v20, v20, v20 row_ror:8 row_mask:0xf bank_mask:0x3
    s_waitcnt vmcnt(4)
    buffer_load_dwordx4 v[88:91], v1, s[16:19], s52 offen offset:1536 nt
    v_dot2_f32_bf16 v22, v72, v12, 0
    v_dot2_f32_bf16 v22, v73, v13, v22
    v_dot2_f32_bf16 v22, v74, v14, v22
    v_dot2_f32_bf16 v22, v75, v15, v22
    v_add_f32_dpp v21, v21, v21 row_ror:8 row_mask:0xf bank_mask:0x3
    s_waitcnt vmcnt(5)
    s_cmp_ge_u32 s75, 3
    s_cbranch_scc1 L_d70
    s_waitcnt vmcnt(3)
    s_cmp_gt_u32 s75, 1
    s_cbranch_scc1 L_d70
    s_waitcnt vmcnt(2)
L_d70:
    buffer_load_dwordx4 v[92:95], v1, s[16:19], s52 offen offset:1792 nt
    v_dot2_f32_bf16 v23, v76, v12, 0
    v_dot2_f32_bf16 v23, v77, v13, v23
    v_dot2_f32_bf16 v23, v78, v14, v23
    v_dot2_f32_bf16 v23, v79, v15, v23
    v_add_f32_dpp v22, v22, v22 row_ror:8 row_mask:0xf bank_mask:0x3
    s_waitcnt vmcnt(3)
    buffer_load_dwordx4 v[96:99], v1, s[16:19], s53 offen offset:0 nt
    s_xor_b32 s37, s85, 199680
    buffer_load_dwordx4 v[216:219], v2, s[20:23], s37 offen offset:0
    v_dot2_f32_bf16 v24, v80, v12, 0
    v_dot2_f32_bf16 v24, v81, v13, v24
    v_dot2_f32_bf16 v24, v82, v14, v24
    v_dot2_f32_bf16 v24, v83, v15, v24
    v_add_f32_dpp v23, v23, v23 row_ror:8 row_mask:0xf bank_mask:0x3
    s_waitcnt vmcnt(5)
    s_cmp_ge_u32 s75, 4
    s_cbranch_scc1 L_d71
    s_waitcnt vmcnt(3)
    s_cmp_gt_u32 s75, 0
    s_cbranch_scc1 L_d71
    s_waitcnt vmcnt(2)
L_d71:
    buffer_load_dwordx4 v[100:103], v1, s[16:19], s53 offen offset:256 nt
    v_readlane_b32 s82, v53, 6
    s_waitcnt lgkmcnt(0)
    s_sub_u32 s43, s43, s82
    s_min_u32 s43, s43, 3
    s_lshl_b32 s43, s43, 2
    s_lshr_b32 s43, 0x3221, s43
    s_and_b32 s43, s43, 7
    v_mov_b32 v55, s43
    s_cmp_lg_u32 s3, 0
    s_cbranch_scc1 L_w72
    ds_write_b32 v56, v55 offset:11264
L_w72:
    v_dot2_f32_bf16 v25, v84, v12, 0
    v_dot2_f32_bf16 v25, v85, v13, v25
    v_dot2_f32_bf16 v25, v86, v14, v25
    v_dot2_f32_bf16 v25, v87, v15, v25
    v_add_f32_dpp v24, v24, v24 row_ror:8 row_mask:0xf bank_mask:0x3
    s_waitcnt vmcnt(3)
    buffer_load_dwordx4 v[104:107], v1, s[16:19], s53 offen offset:512 nt
    v_dot2_f32_bf16 v26, v88, v12, 0
    v_dot2_f32_bf16 v26, v89, v13, v26
    v_dot2_f32_bf16 v26, v90, v14, v26
    v_dot2_f32_bf16 v26, v91, v15, v26
    v_add_f32_dpp v25, v25, v25 row_ror:8 row_mask:0xf bank_mask:0x3
    s_waitcnt vmcnt(4)
    s_cmp_ge_u32 s75, 3
    s_cbranch_scc1 L_d73
    s_waitcnt vmcnt(3)
    s_cmp_gt_u32 s75, 1
    s_cbranch_scc1 L_d73
    s_waitcnt vmcnt(1)
L_d73:
    buffer_load_dwordx4 v[108:111], v1, s[16:19], s53 offen offset:768 nt
    s_xor_b32 s37, s85, 232448
    buffer_load_dwordx4 v[220:223], v2, s[20:23], s37 offen offset:0
    v_dot2_f32_bf16 v27, v92, v12, 0
    v_dot2_f32_bf16 v27, v93, v13, v27
    v_dot2_f32_bf16 v27, v94, v14, v27
    v_dot2_f32_bf16 v27, v95, v15, v27
    v_add_f32_dpp v26, v26, v26 row_ror:8 row_mask:0xf bank_mask:0x3
    s_waitcnt vmcnt(3)
    buffer_load_dwordx4 v[112:115], v1, s[16:19], s53 offen offset:1024 nt
    ds_read_b32 v55, v56 offset:11264
    v_dot2_f32_bf16 v28, v96, v16, 0
    v_dot2_f32_bf16 v28, v97, v17, v28
    v_dot2_f32_bf16 v28, v98, v18, v28
    v_dot2_f32_bf16 v28, v99, v19, v28
    v_add_f32_dpp v27, v27, v27 row_ror:8 row_mask:0xf bank_mask:0x3
    s_waitcnt vmcnt(4)
    s_cmp_ge_u32 s75, 4
    s_cbranch_scc1 L_d74
    s_waitcnt vmcnt(3)
    s_cmp_gt_u32 s75, 0
    s_cbranch_scc1 L_d74
    s_waitcnt vmcnt(2)
L_d74:
    buffer_load_dwordx4 v[116:119], v1, s[16:19], s53 offen offset:1280 nt
    s_waitcnt lgkmcnt(0)
    v_readfirstlane_b32 s75, v55
    s_nop 0
    v_dot2_f32_bf16 v29, v100, v16, 0
    v_dot2_f32_bf16 v29, v101, v17, v29
    v_dot2_f32_bf16 v29, v102, v18, v29
    v_dot2_f32_bf16 v29, v103, v19, v29
    v_add_f32_dpp v20, v28, v28 row_ror:8 row_mask:0xf bank_mask:0xc
    s_waitcnt vmcnt(3)
    buffer_load_dwordx4 v[120:123], v1, s[16:19], s53 offen offset:1536 nt
    v_dot2_f32_bf16 v28, v104, v16, 0
    v_dot2_f32_bf16 v28, v105, v17, v28
    v_dot2_f32_bf16 v28, v106, v18, v28
    v_dot2_f32_bf16 v28, v107, v19, v28
    v_add_f32_dpp v20, v20, v20 row_half_mirror row_mask:0xf bank_mask:0xf
    v_add_f32_dpp v21, v29, v29 row_ror:8 row_mask:0xf bank_mask:0xc
    s_waitcnt vmcnt(4)
    s_cmp_ge_u32 s75, 3
    s_cbranch_scc1 L_d75
    s_waitcnt vmcnt(2)
    s_cmp_gt_u32 s75, 1
    s_cbranch_scc1 L_d75
    s_waitcnt vmcnt(1)
L_d75:
    buffer_load_dwordx4 v[124:127], v1, s[16:19], s53 offen offset:1792 nt
    v_dot2_f32_bf16 v29, v108, v16, 0
    v_dot2_f32_bf16 v29, v109, v17, v29
    v_dot2_f32_bf16 v29, v110, v18, v29
    v_dot2_f32_bf16 v29, v111, v19, v29
    v_add_f32_dpp v20, v20, v20 quad_perm:[1,0,3,2] row_mask:0xf bank_mask:0xf
    v_add_f32_dpp v21, v21, v21 row_half_mirror row_mask:0xf bank_mask:0xf
    v_add_f32_dpp v22, v28, v28 row_ror:8 row_mask:0xf bank_mask:0xc
    s_waitcnt vmcnt(3)
    s_xor_b32 s34, s32, 0
    s_add_u32 s35, s34, 0x80000
    buffer_load_dwordx4 v[64:67], v1, s[48:51], s34 offen offset:0 nt
    v_dot2_f32_bf16 v28, v112, v16, 0
    v_dot2_f32_bf16 v28, v113, v17, v28
    v_dot2_f32_bf16 v28, v114, v18, v28
    v_dot2_f32_bf16 v28, v115, v19, v28
    v_add_f32_dpp v20, v20, v20 quad_perm:[2,3,0,1] row_mask:0xf bank_mask:0xf
    v_add_f32_dpp v21, v21, v21 quad_perm:[1,0,3,2] row_mask:0xf bank_mask:0xf
    v_add_f32_dpp v22, v22, v22 row_half_mirror row_mask:0xf bank_mask:0xf
    v_add_f32_dpp v23, v29, v29 row_ror:8 row_mask:0xf bank_mask:0xc
    s_waitcnt vmcnt(3)
    buffer_load_dwordx4 v[68:71], v1, s[48:51], s34 offen offset:256 nt
    buffer_load_dwordx4 v[72:75], v1, s[48:51], s34 offen offset:512 nt
    buffer_load_dwordx4 v[76:79], v1, s[48:51], s34 offen offset:768 nt
    v_dot2_f32_bf16 v29, v116, v16, 0
    v_dot2_f32_bf16 v29, v117, v17, v29
    v_dot2_f32_bf16 v29, v118, v18, v29
    v_dot2_f32_bf16 v29, v119, v19, v29
    v_and_b32 v30, v20, v4
    v_sub_f32 v20, v20, v30
    v_add_f32_dpp v21, v21, v21 quad_perm:[2,3,0,1] row_mask:0xf bank_mask:0xf
    v_add_f32_dpp v22, v22, v22 quad_perm:[1,0,3,2] row_mask:0xf bank_mask:0xf
    v_add_f32_dpp v23, v23, v23 row_half_mirror row_mask:0xf bank_mask:0xf
    v_add_f32_dpp v24, v28, v28 row_ror:8 row_mask:0xf bank_mask:0xc
    s_waitcnt vmcnt(5)
    buffer_load_dwordx4 v[80:83], v1, s[48:51], s34 offen offset:1024 nt
    buffer_load_dwordx4 v[84:87], v1, s[48:51], s34 offen offset:1280 nt
    buffer_load_dwordx4 v[88:91], v1, s[48:51], s34 offen offset:1536 nt
    v_dot2_f32_bf16 v28, v120, v16, 0
    v_dot2_f32_bf16 v28, v121, v17, v28
    v_dot2_f32_bf16 v28, v122, v18, v28
    v_dot2_f32_bf16 v28, v123, v19, v28
    v_and_b32 v31, v21, v4
    v_sub_f32 v21, v21, v31
    v_add_f32_dpp v22, v22, v22 quad_perm:[2,3,0,1] row_mask:0xf bank_mask:0xf
    v_add_f32_dpp v23, v23, v23 quad_perm:[1,0,3,2] row_mask:0xf bank_mask:0xf
    v_add_f32_dpp v24, v24, v24 row_half_mirror row_mask:0xf bank_mask:0xf
    v_add_f32_dpp v25, v29, v29 row_ror:8 row_mask:0xf bank_mask:0xc
    s_waitcnt vmcnt(7)
    buffer_load_dwordx4 v[92:95], v1, s[48:51], s34 offen offset:1792 nt
    buffer_load_dwordx4 v[96:99], v1, s[48:51], s35 offen offset:0 nt
    buffer_load_dwordx4 v[100:103], v1, s[48:51], s35 offen offset:256 nt
    v_dot2_f32_bf16 v29, v124, v16, 0
    v_dot2_f32_bf16 v29, v125, v17, v29
    v_dot2_f32_bf16 v29, v126, v18, v29
    v_dot2_f32_bf16 v29, v127, v19, v29
    v_and_b32 v30, v22, v4
    v_sub_f32 v22, v22, v30
    v_add_f32_dpp v23, v23, v23 quad_perm:[2,3,0,1] row_mask:0xf bank_mask:0xf
    v_add_f32_dpp v24, v24, v24 quad_perm:[1,0,3,2] row_mask:0xf bank_mask:0xf
    v_add_f32_dpp v25, v25, v25 row_half_mirror row_mask:0xf bank_mask:0xf
    v_add_f32_dpp v26, v28, v28 row_ror:8 row_mask:0xf bank_mask:0xc
    v_and_b32 v31, v23, v4
    v_sub_f32 v23, v23, v31
    v_add_f32_dpp v24, v24, v24 quad_perm:[2,3,0,1] row_mask:0xf bank_mask:0xf
    v_add_f32_dpp v25, v25, v25 quad_perm:[1,0,3,2] row_mask:0xf bank_mask:0xf
    v_add_f32_dpp v26, v26, v26 row_half_mirror row_mask:0xf bank_mask:0xf
    v_add_f32_dpp v27, v29, v29 row_ror:8 row_mask:0xf bank_mask:0xc
    v_and_b32 v30, v24, v4
    v_sub_f32 v24, v24, v30
    v_add_f32_dpp v25, v25, v25 quad_perm:[2,3,0,1] row_mask:0xf bank_mask:0xf
    v_add_f32_dpp v26, v26, v26 quad_perm:[1,0,3,2] row_mask:0xf bank_mask:0xf
    v_add_f32_dpp v27, v27, v27 row_half_mirror row_mask:0xf bank_mask:0xf
    v_and_b32 v31, v25, v4
    v_sub_f32 v25, v25, v31
    v_add_f32_dpp v26, v26, v26 quad_perm:[2,3,0,1] row_mask:0xf bank_mask:0xf
    v_add_f32_dpp v27, v27, v27 quad_perm:[1,0,3,2] row_mask:0xf bank_mask:0xf
    v_and_b32 v30, v26, v4
    v_sub_f32 v26, v26, v30
    v_add_f32_dpp v27, v27, v27 quad_perm:[2,3,0,1] row_mask:0xf bank_mask:0xf
    v_and_b32 v31, v27, v4
    v_sub_f32 v27, v27, v31
    v_perm_b32 v20, v21, v20, s40
    v_perm_b32 v21, v23, v22, s40
    v_perm_b32 v22, v25, v24, s40
    v_perm_b32 v23, v27, v26, s40
    v_cndmask_b32 v48, v48, v20, s[54:55]
    v_cndmask_b32 v49, v49, v21, s[54:55]
    v_cndmask_b32 v50, v50, v22, s[54:55]
    v_cndmask_b32 v51, v51, v23, s[54:55]
    s_waitcnt vmcnt(14)
    s_nop 0
    v_mfma_f32_16x16x32_bf16 v[224:227], v[192:195], v[48:51], v[224:227]
    v_mfma_f32_16x16x32_bf16 v[228:231], v[196:199], v[48:51], v[228:231]
    v_mfma_f32_16x16x32_bf16 v[232:235], v[200:203], v[48:51], v[232:235]
    v_mfma_f32_16x16x32_bf16 v[236:239], v[204:207], v[48:51], v[236:239]
    v_mfma_f32_16x16x32_bf16 v[240:243], v[208:211], v[48:51], v[240:243]
    v_mfma_f32_16x16x32_bf16 v[244:247], v[212:215], v[48:51], v[244:247]
    v_mfma_f32_16x16x32_bf16 v[248:251], v[216:219], v[48:51], v[248:251]
    v_mfma_f32_16x16x32_bf16 v[252:255], v[220:223], v[48:51], v[252:255]
    v_bfe_u32 v5, v0, 3, 1
    v_lshrrev_b32 v6, 4, v0
    v_lshlrev_b32 v7, 8, v5
    v_lshrrev_b32 v28, 1, v6
    v_lshl_add_u32 v7, v28, 9, v7
    v_and_b32 v28, 1, v6
    v_lshl_add_u32 v7, v28, 4, v7
    s_lshl_b32 s38, s3, 10
    v_add_u32 v7, s38, v7
    v_add_f32_dpp v224, v224, v224 quad_perm:[1,0,3,2] row_mask:0xf bank_mask:0xf
    v_add_f32_dpp v225, v225, v225 quad_perm:[1,0,3,2] row_mask:0xf bank_mask:0xf
    v_add_f32_dpp v226, v226, v226 quad_perm:[1,0,3,2] row_mask:0xf bank_mask:0xf
    v_add_f32_dpp v227, v227, v227 quad_perm:[1,0,3,2] row_mask:0xf bank_mask:0xf
    v_add_f32_dpp v228, v228, v228 quad_perm:[1,0,3,2] row_mask:0xf bank_mask:0xf
    v_add_f32_dpp v229, v229, v229 quad_perm:[1,0,3,2] row_mask:0xf bank_mask:0xf
    v_add_f32_dpp v230, v230, v230 quad_perm:[1,0,3,2] row_mask:0xf bank_mask:0xf
    v_add_f32_dpp v231, v231, v231 quad_perm:[1,0,3,2] row_mask:0xf bank_mask:0xf
    v_add_f32_dpp v232, v232, v232 quad_perm:[1,0,3,2] row_mask:0xf bank_mask:0xf
    v_add_f32_dpp v233, v233, v233 quad_perm:[1,0,3,2] row_mask:0xf bank_mask:0xf
    v_add_f32_dpp v234, v234, v234 quad_perm:[1,0,3,2] row_mask:0xf bank_mask:0xf
    v_add_f32_dpp v235, v235, v235 quad_perm:[1,0,3,2] row_mask:0xf bank_mask:0xf
    v_add_f32_dpp v236, v236, v236 quad_perm:[1,0,3,2] row_mask:0xf bank_mask:0xf
    v_add_f32_dpp v237, v237, v237 quad_perm:[1,0,3,2] row_mask:0xf bank_mask:0xf
    v_add_f32_dpp v238, v238, v238 quad_perm:[1,0,3,2] row_mask:0xf bank_mask:0xf
    v_add_f32_dpp v239, v239, v239 quad_perm:[1,0,3,2] row_mask:0xf bank_mask:0xf
    v_add_f32_dpp v240, v240, v240 quad_perm:[1,0,3,2] row_mask:0xf bank_mask:0xf
    v_add_f32_dpp v241, v241, v241 quad_perm:[1,0,3,2] row_mask:0xf bank_mask:0xf
    v_add_f32_dpp v242, v242, v242 quad_perm:[1,0,3,2] row_mask:0xf bank_mask:0xf
    v_add_f32_dpp v243, v243, v243 quad_perm:[1,0,3,2] row_mask:0xf bank_mask:0xf
    v_add_f32_dpp v244, v244, v244 quad_perm:[1,0,3,2] row_mask:0xf bank_mask:0xf
    v_add_f32_dpp v245, v245, v245 quad_perm:[1,0,3,2] row_mask:0xf bank_mask:0xf
    v_add_f32_dpp v246, v246, v246 quad_perm:[1,0,3,2] row_mask:0xf bank_mask:0xf
    v_add_f32_dpp v247, v247, v247 quad_perm:[1,0,3,2] row_mask:0xf bank_mask:0xf
    v_add_f32_dpp v248, v248, v248 quad_perm:[1,0,3,2] row_mask:0xf bank_mask:0xf
    v_add_f32_dpp v249, v249, v249 quad_perm:[1,0,3,2] row_mask:0xf bank_mask:0xf
    v_add_f32_dpp v250, v250, v250 quad_perm:[1,0,3,2] row_mask:0xf bank_mask:0xf
    v_add_f32_dpp v251, v251, v251 quad_perm:[1,0,3,2] row_mask:0xf bank_mask:0xf
    v_add_f32_dpp v252, v252, v252 quad_perm:[1,0,3,2] row_mask:0xf bank_mask:0xf
    v_add_f32_dpp v253, v253, v253 quad_perm:[1,0,3,2] row_mask:0xf bank_mask:0xf
    v_add_f32_dpp v254, v254, v254 quad_perm:[1,0,3,2] row_mask:0xf bank_mask:0xf
    v_add_f32_dpp v255, v255, v255 quad_perm:[1,0,3,2] row_mask:0xf bank_mask:0xf
    s_mov_b32 exec_lo, 0x01010101
    s_mov_b32 exec_hi, 0x04040404
    ds_write_b128 v7, v[224:227] offset:0
    ds_write_b128 v7, v[228:231] offset:32
    ds_write_b128 v7, v[232:235] offset:64
    ds_write_b128 v7, v[236:239] offset:96
    ds_write_b128 v7, v[240:243] offset:128
    ds_write_b128 v7, v[244:247] offset:160
    ds_write_b128 v7, v[248:251] offset:192
    ds_write_b128 v7, v[252:255] offset:224
    s_mov_b64 exec, -1
    v_lshlrev_b32 v7, 2, v0
    s_waitcnt lgkmcnt(0)
    s_barrier
    ds_read2st64_b32 v[224:225], v7 offset0:0 offset1:1
    ds_read2st64_b32 v[226:227], v7 offset0:2 offset1:3
    ds_read2st64_b32 v[228:229], v7 offset0:4 offset1:5
    ds_read2st64_b32 v[230:231], v7 offset0:6 offset1:7
    ds_read2st64_b32 v[232:233], v7 offset0:8 offset1:9
    ds_read2st64_b32 v[234:235], v7 offset0:10 offset1:11
    ds_read2st64_b32 v[236:237], v7 offset0:12 offset1:13
    ds_read2st64_b32 v[238:239], v7 offset0:14 offset1:15
    ds_read2st64_b32 v[240:241], v7 offset0:16 offset1:17
    ds_read2st64_b32 v[242:243], v7 offset0:18 offset1:19
    ds_read2st64_b32 v[244:245], v7 offset0:20 offset1:21
    ds_read2st64_b32 v[246:247], v7 offset0:22 offset1:23
    ds_read2st64_b32 v[248:249], v7 offset0:24 offset1:25
    ds_read2st64_b32 v[250:251], v7 offset0:26 offset1:27
    ds_read2st64_b32 v[252:253], v7 offset0:28 offset1:29
    ds_read2st64_b32 v[254:255], v7 offset0:30 offset1:31
    s_lshl_b32 s38, s3, 8
    v_add_u32 v7, s38, v7
    v_lshlrev_b32 v6, 6, v6
    v_add_u32 v6, s38, v6
    s_waitcnt lgkmcnt(0)
    v_pk_add_f32 v[224:225], v[224:225], v[226:227]
    v_pk_add_f32 v[228:229], v[228:229], v[230:231]
    v_pk_add_f32 v[232:233], v[232:233], v[234:235]
    v_pk_add_f32 v[236:237], v[236:237], v[238:239]
    v_pk_add_f32 v[240:241], v[240:241], v[242:243]
    v_pk_add_f32 v[244:245], v[244:245], v[246:247]
    v_pk_add_f32 v[248:249], v[248:249], v[250:251]
    v_pk_add_f32 v[252:253], v[252:253], v[254:255]
    v_pk_add_f32 v[224:225], v[224:225], v[228:229]
    v_pk_add_f32 v[232:233], v[232:233], v[236:237]
    v_pk_add_f32 v[240:241], v[240:241], v[244:245]
    v_pk_add_f32 v[248:249], v[248:249], v[252:253]
    v_pk_add_f32 v[224:225], v[224:225], v[232:233]
    v_pk_add_f32 v[240:241], v[240:241], v[248:249]
    v_pk_add_f32 v[224:225], v[224:225], v[240:241]
    s_nop 1
    v_max_f32_dpp v226, v224, v224 quad_perm:[1,0,3,2] row_mask:0xf bank_mask:0xf
    v_max_f32_dpp v227, v225, v225 quad_perm:[1,0,3,2] row_mask:0xf bank_mask:0xf
    s_nop 0
    v_max_f32_dpp v226, v226, v226 quad_perm:[2,3,0,1] row_mask:0xf bank_mask:0xf
    v_max_f32_dpp v227, v227, v227 quad_perm:[2,3,0,1] row_mask:0xf bank_mask:0xf
    s_nop 0
    v_max_f32_dpp v226, v226, v226 row_half_mirror row_mask:0xf bank_mask:0xf
    v_max_f32_dpp v227, v227, v227 row_half_mirror row_mask:0xf bank_mask:0xf
    s_nop 0
    v_max_f32_dpp v226, v226, v226 row_mirror row_mask:0xf bank_mask:0xf
    v_max_f32_dpp v227, v227, v227 row_mirror row_mask:0xf bank_mask:0xf
    s_nop 0
    v_max_f32_dpp v226, v226, v226 row_bcast:15 row_mask:0xa bank_mask:0xf
    v_max_f32_dpp v227, v227, v227 row_bcast:15 row_mask:0xa bank_mask:0xf
    s_nop 0
    v_max_f32_dpp v226, v226, v226 row_bcast:31 row_mask:0xc bank_mask:0xf
    v_max_f32_dpp v227, v227, v227 row_bcast:31 row_mask:0xc bank_mask:0xf
    v_readlane_b32 s44, v226, 63
    v_readlane_b32 s45, v227, 63
    s_nop 0
    v_subrev_f32 v224, s44, v224
    v_subrev_f32 v225, s45, v225
    v_mul_f32 v224, s42, v224
    v_mul_f32 v225, s42, v225
    v_exp_f32 v224, v224
    v_exp_f32 v225, v225
    s_nop 0
    v_add_f32_dpp v226, v224, v224 quad_perm:[1,0,3,2] row_mask:0xf bank_mask:0xf
    v_add_f32_dpp v227, v225, v225 quad_perm:[1,0,3,2] row_mask:0xf bank_mask:0xf
    s_nop 0
    v_add_f32_dpp v226, v226, v226 quad_perm:[2,3,0,1] row_mask:0xf bank_mask:0xf
    v_add_f32_dpp v227, v227, v227 quad_perm:[2,3,0,1] row_mask:0xf bank_mask:0xf
    s_nop 0
    v_add_f32_dpp v226, v226, v226 row_half_mirror row_mask:0xf bank_mask:0xf
    v_add_f32_dpp v227, v227, v227 row_half_mirror row_mask:0xf bank_mask:0xf
    s_nop 0
    v_add_f32_dpp v226, v226, v226 row_mirror row_mask:0xf bank_mask:0xf
    v_add_f32_dpp v227, v227, v227 row_mirror row_mask:0xf bank_mask:0xf
    s_nop 0
    v_add_f32_dpp v226, v226, v226 row_bcast:15 row_mask:0xa bank_mask:0xf
    v_add_f32_dpp v227, v227, v227 row_bcast:15 row_mask:0xa bank_mask:0xf
    s_nop 0
    v_add_f32_dpp v226, v226, v226 row_bcast:31 row_mask:0xc bank_mask:0xf
    v_add_f32_dpp v227, v227, v227 row_bcast:31 row_mask:0xc bank_mask:0xf
    v_readlane_b32 s44, v226, 63
    v_readlane_b32 s45, v227, 63
    s_nop 0
    v_rcp_f32 v226, s44
    v_rcp_f32 v227, s45
    v_mul_f32 v224, v224, v226
    v_mul_f32 v225, v225, v227
    v_cvt_pk_bf16_f32 v226, v225, v224
    ds_write_b32 v7, v226 offset:8192
    s_waitcnt lgkmcnt(0)
    ds_read_b128 v[32:35], v6 offset:8192
    ds_read_b128 v[36:39], v6 offset:8208
    ds_read_b128 v[40:43], v6 offset:8224
    ds_read_b128 v[44:47], v6 offset:8240
    s_waitcnt lgkmcnt(0)
    v_mov_b32 v240, v52
    v_mov_b32 v241, v53
    v_mov_b32 v242, v54
    v_mov_b32 v244, 0
    s_waitcnt vmcnt(25)
    v_perm_b32 v196, v32, v32, v8
    v_perm_b32 v197, v32, v32, v9
    v_perm_b32 v198, v32, v32, v10
    v_perm_b32 v199, v32, v32, v11
    v_perm_b32 v200, v33, v33, v8
    v_perm_b32 v201, v33, v33, v9
    v_perm_b32 v202, v33, v33, v10
    v_perm_b32 v203, v33, v33, v11
    v_mfma_f32_16x16x32_bf16 v[192:195], v[128:131], v[196:199], 0
    v_perm_b32 v204, v34, v34, v8
    v_perm_b32 v205, v34, v34, v9
    v_perm_b32 v206, v34, v34, v10
    v_perm_b32 v207, v34, v34, v11
    v_mfma_f32_16x16x32_bf16 v[192:195], v[132:135], v[200:203], v[192:195]
    v_perm_b32 v208, v35, v35, v8
    v_perm_b32 v209, v35, v35, v9
    v_perm_b32 v210, v35, v35, v10
    v_perm_b32 v211, v35, v35, v11
    v_mfma_f32_16x16x32_bf16 v[192:195], v[136:139], v[204:207], v[192:195]
    v_perm_b32 v196, v36, v36, v8
    v_perm_b32 v197, v36, v36, v9
    v_perm_b32 v198, v36, v36, v10
    v_perm_b32 v199, v36, v36, v11
    v_mfma_f32_16x16x32_bf16 v[192:195], v[140:143], v[208:211], v[192:195]
    v_perm_b32 v200, v37, v37, v8
    v_perm_b32 v201, v37, v37, v9
    v_perm_b32 v202, v37, v37, v10
    v_perm_b32 v203, v37, v37, v11
    v_mfma_f32_16x16x32_bf16 v[192:195], v[144:147], v[196:199], v[192:195]
    v_perm_b32 v204, v38, v38, v8
    v_perm_b32 v205, v38, v38, v9
    v_perm_b32 v206, v38, v38, v10
    v_perm_b32 v207, v38, v38, v11
    v_mfma_f32_16x16x32_bf16 v[192:195], v[148:151], v[200:203], v[192:195]
    v_perm_b32 v208, v39, v39, v8
    v_perm_b32 v209, v39, v39, v9
    v_perm_b32 v210, v39, v39, v10
    v_perm_b32 v211, v39, v39, v11
    v_mfma_f32_16x16x32_bf16 v[192:195], v[152:155], v[204:207], v[192:195]
    v_perm_b32 v196, v40, v40, v8
    v_perm_b32 v197, v40, v40, v9
    v_perm_b32 v198, v40, v40, v10
    v_perm_b32 v199, v40, v40, v11
    v_mfma_f32_16x16x32_bf16 v[192:195], v[156:159], v[208:211], v[192:195]
    v_perm_b32 v200, v41, v41, v8
    v_perm_b32 v201, v41, v41, v9
    v_perm_b32 v202, v41, v41, v10
    v_perm_b32 v203, v41, v41, v11
    v_mfma_f32_16x16x32_bf16 v[192:195], v[160:163], v[196:199], v[192:195]
    v_perm_b32 v204, v42, v42, v8
    v_perm_b32 v205, v42, v42, v9
    v_perm_b32 v206, v42, v42, v10
    v_perm_b32 v207, v42, v42, v11
    v_mfma_f32_16x16x32_bf16 v[192:195], v[164:167], v[200:203], v[192:195]
    v_perm_b32 v208, v43, v43, v8
    v_perm_b32 v209, v43, v43, v9
    v_perm_b32 v210, v43, v43, v10
    v_perm_b32 v211, v43, v43, v11
    v_mfma_f32_16x16x32_bf16 v[192:195], v[168:171], v[204:207], v[192:195]
    v_perm_b32 v196, v44, v44, v8
    v_perm_b32 v197, v44, v44, v9
    v_perm_b32 v198, v44, v44, v10
    v_perm_b32 v199, v44, v44, v11
    v_mfma_f32_16x16x32_bf16 v[192:195], v[172:175], v[208:211], v[192:195]
    v_perm_b32 v200, v45, v45, v8
    v_perm_b32 v201, v45, v45, v9
    v_perm_b32 v202, v45, v45, v10
    v_perm_b32 v203, v45, v45, v11
    v_mfma_f32_16x16x32_bf16 v[192:195], v[176:179], v[196:199], v[192:195]
    v_perm_b32 v204, v46, v46, v8
    v_perm_b32 v205, v46, v46, v9
    v_perm_b32 v206, v46, v46, v10
    v_perm_b32 v207, v46, v46, v11
    v_mfma_f32_16x16x32_bf16 v[192:195], v[180:183], v[200:203], v[192:195]
    v_perm_b32 v208, v47, v47, v8
    v_perm_b32 v209, v47, v47, v9
    v_perm_b32 v210, v47, v47, v10
    v_perm_b32 v211, v47, v47, v11
    v_mfma_f32_16x16x32_bf16 v[192:195], v[184:187], v[204:207], v[192:195]
    s_nop 0
    v_mfma_f32_16x16x32_bf16 v[192:195], v[188:191], v[208:211], v[192:195]
    s_nop 7
    v_permlane32_swap_b32 v192, v194
    v_permlane32_swap_b32 v193, v195
    s_nop 1
    v_permlane16_swap_b32 v192, v193
    v_permlane16_swap_b32 v194, v195
    v_and_b32 v20, s41, v192
    v_and_b32 v21, s41, v193
    v_and_b32 v22, s41, v194
    v_and_b32 v23, s41, v195
    v_sub_f32 v20, v192, v20
    v_sub_f32 v21, v193, v21
    v_sub_f32 v22, v194, v22
    v_sub_f32 v23, v195, v23
    v_perm_b32 v20, v192, v20, s40
    v_perm_b32 v21, v193, v21, s40
    v_perm_b32 v22, v194, v22, s40
    v_perm_b32 v23, v195, v23, s40
    v_mov_b32_dpp v28, v20 row_newbcast:0 row_mask:0xf bank_mask:0xf
    v_perm_b32 v48, v28, v28, v8
    v_perm_b32 v49, v28, v28, v9
    v_perm_b32 v50, v28, v28, v10
    v_perm_b32 v51, v28, v28, v11
    v_mov_b32_dpp v29, v20 row_newbcast:1 row_mask:0xf bank_mask:0xf
    v_perm_b32 v52, v29, v29, v8
    v_perm_b32 v53, v29, v29, v9
    v_perm_b32 v54, v29, v29, v10
    v_perm_b32 v55, v29, v29, v11
    s_waitcnt vmcnt(9)
    s_add_u32 s38, s46, 0
    v_xor_b32 v3, 0x800, v3
    buffer_load_dwordx4 v[128:131], v3, s[24:27], s38 offen offset:0
    v_mfma_f32_16x16x32_bf16 v[12:15], v[64:67], v[48:51], 0
    v_mov_b32_dpp v28, v20 row_newbcast:2 row_mask:0xf bank_mask:0xf
    v_perm_b32 v56, v28, v28, v8
    v_perm_b32 v57, v28, v28, v9
    v_perm_b32 v58, v28, v28, v10
    v_perm_b32 v59, v28, v28, v11
    s_waitcnt vmcnt(9)
    v_mfma_f32_16x16x32_bf16 v[12:15], v[68:71], v[52:55], v[12:15]
    v_mov_b32_dpp v29, v20 row_newbcast:3 row_mask:0xf bank_mask:0xf
    v_perm_b32 v60, v29, v29, v8
    v_perm_b32 v61, v29, v29, v9
    v_perm_b32 v62, v29, v29, v10
    v_perm_b32 v63, v29, v29, v11
    s_waitcnt vmcnt(8)
    v_mfma_f32_16x16x32_bf16 v[12:15], v[72:75], v[56:59], v[12:15]
    v_mov_b32_dpp v28, v20 row_newbcast:4 row_mask:0xf bank_mask:0xf
    v_perm_b32 v48, v28, v28, v8
    v_perm_b32 v49, v28, v28, v9
    v_perm_b32 v50, v28, v28, v10
    v_perm_b32 v51, v28, v28, v11
    s_waitcnt vmcnt(7)
    v_mfma_f32_16x16x32_bf16 v[12:15], v[76:79], v[60:63], v[12:15]
    v_mov_b32_dpp v29, v20 row_newbcast:5 row_mask:0xf bank_mask:0xf
    v_perm_b32 v52, v29, v29, v8
    v_perm_b32 v53, v29, v29, v9
    v_perm_b32 v54, v29, v29, v10
    v_perm_b32 v55, v29, v29, v11
    s_waitcnt vmcnt(6)
    s_add_u32 s38, s46, 4096
    buffer_load_dwordx4 v[132:135], v3, s[24:27], s38 offen offset:0
    v_mfma_f32_16x16x32_bf16 v[12:15], v[80:83], v[48:51], v[12:15]
    v_mov_b32_dpp v28, v20 row_newbcast:6 row_mask:0xf bank_mask:0xf
    v_perm_b32 v56, v28, v28, v8
    v_perm_b32 v57, v28, v28, v9
    v_perm_b32 v58, v28, v28, v10
    v_perm_b32 v59, v28, v28, v11
    s_waitcnt vmcnt(6)
    v_mfma_f32_16x16x32_bf16 v[12:15], v[84:87], v[52:55], v[12:15]
    v_mov_b32_dpp v29, v20 row_newbcast:7 row_mask:0xf bank_mask:0xf
    v_perm_b32 v60, v29, v29, v8
    v_perm_b32 v61, v29, v29, v9
    v_perm_b32 v62, v29, v29, v10
    v_perm_b32 v63, v29, v29, v11
    s_waitcnt vmcnt(4)
    buffer_load_dwordx4 v[104:107], v1, s[48:51], s35 offen offset:512 nt
    v_mfma_f32_16x16x32_bf16 v[12:15], v[88:91], v[56:59], v[12:15]
    v_mov_b32_dpp v28, v20 row_newbcast:8 row_mask:0xf bank_mask:0xf
    v_perm_b32 v48, v28, v28, v8
    v_perm_b32 v49, v28, v28, v9
    v_perm_b32 v50, v28, v28, v10
    v_perm_b32 v51, v28, v28, v11
    s_waitcnt vmcnt(5)
    s_cmp_ge_u32 s75, 3
    s_cbranch_scc1 L_d76
    s_waitcnt vmcnt(4)
    s_cmp_gt_u32 s75, 1
    s_cbranch_scc1 L_d76
    s_waitcnt vmcnt(3)
L_d76:
    buffer_load_dwordx4 v[108:111], v1, s[48:51], s35 offen offset:768 nt
    v_mfma_f32_16x16x32_bf16 v[12:15], v[92:95], v[60:63], v[12:15]
    v_mov_b32_dpp v29, v20 row_newbcast:9 row_mask:0xf bank_mask:0xf
    v_perm_b32 v52, v29, v29, v8
    v_perm_b32 v53, v29, v29, v9
    v_perm_b32 v54, v29, v29, v10
    v_perm_b32 v55, v29, v29, v11
    s_waitcnt vmcnt(4)
    buffer_load_dwordx4 v[112:115], v1, s[48:51], s35 offen offset:1024 nt
    s_add_u32 s38, s46, 8192
    buffer_load_dwordx4 v[136:139], v3, s[24:27], s38 offen offset:0
    v_mfma_f32_16x16x32_bf16 v[16:19], v[96:99], v[48:51], 0
    v_mov_b32_dpp v28, v20 row_newbcast:10 row_mask:0xf bank_mask:0xf
    v_perm_b32 v56, v28, v28, v8
    v_perm_b32 v57, v28, v28, v9
    v_perm_b32 v58, v28, v28, v10
    v_perm_b32 v59, v28, v28, v11
    s_waitcnt vmcnt(6)
    s_cmp_ge_u32 s75, 4
    s_cbranch_scc1 L_d77
    s_waitcnt vmcnt(3)
    s_cmp_gt_u32 s75, 0
    s_cbranch_scc1 L_d77
    s_waitcnt vmcnt(2)
L_d77:
    buffer_load_dwordx4 v[116:119], v1, s[48:51], s35 offen offset:1280 nt
    v_mfma_f32_16x16x32_bf16 v[16:19], v[100:103], v[52:55], v[16:19]
    v_mov_b32_dpp v29, v20 row_newbcast:11 row_mask:0xf bank_mask:0xf
    v_perm_b32 v60, v29, v29, v8
    v_perm_b32 v61, v29, v29, v9
    v_perm_b32 v62, v29, v29, v10
    v_perm_b32 v63, v29, v29, v11
    s_waitcnt vmcnt(3)
    buffer_load_dwordx4 v[120:123], v1, s[48:51], s35 offen offset:1536 nt
    v_mfma_f32_16x16x32_bf16 v[16:19], v[104:107], v[56:59], v[16:19]
    v_mov_b32_dpp v28, v20 row_newbcast:12 row_mask:0xf bank_mask:0xf
    v_perm_b32 v48, v28, v28, v8
    v_perm_b32 v49, v28, v28, v9
    v_perm_b32 v50, v28, v28, v10
    v_perm_b32 v51, v28, v28, v11
    s_waitcnt vmcnt(4)
    s_cmp_ge_u32 s75, 3
    s_cbranch_scc1 L_d78
    s_waitcnt vmcnt(3)
    s_cmp_gt_u32 s75, 1
    s_cbranch_scc1 L_d78
    s_waitcnt vmcnt(1)
L_d78:
    buffer_load_dwordx4 v[124:127], v1, s[48:51], s35 offen offset:1792 nt
    s_add_u32 s38, s46, 12288
    buffer_load_dwordx4 v[140:143], v3, s[24:27], s38 offen offset:0
    v_mfma_f32_16x16x32_bf16 v[16:19], v[108:111], v[60:63], v[16:19]
    v_mov_b32_dpp v29, v20 row_newbcast:13 row_mask:0xf bank_mask:0xf
    v_perm_b32 v52, v29, v29, v8
    v_perm_b32 v53, v29, v29, v9
    v_perm_b32 v54, v29, v29, v10
    v_perm_b32 v55, v29, v29, v11
    s_waitcnt vmcnt(3)
    s_xor_b32 s52, s33, 0
    s_add_u32 s53, s52, 0x80000
    buffer_load_dwordx4 v[64:67], v1, s[48:51], s52 offen offset:0 nt
    v_mfma_f32_16x16x32_bf16 v[16:19], v[112:115], v[48:51], v[16:19]
    v_mov_b32_dpp v28, v20 row_newbcast:14 row_mask:0xf bank_mask:0xf
    v_perm_b32 v56, v28, v28, v8
    v_perm_b32 v57, v28, v28, v9
    v_perm_b32 v58, v28, v28, v10
    v_perm_b32 v59, v28, v28, v11
    s_waitcnt vmcnt(4)
    s_cmp_ge_u32 s75, 4
    s_cbranch_scc1 L_d79
    s_waitcnt vmcnt(3)
    s_cmp_gt_u32 s75, 0
    s_cbranch_scc1 L_d79
    s_waitcnt vmcnt(2)
L_d79:
    buffer_load_dwordx4 v[68:71], v1, s[48:51], s52 offen offset:256 nt
    v_mfma_f32_16x16x32_bf16 v[16:19], v[116:119], v[52:55], v[16:19]
    v_mov_b32_dpp v29, v20 row_newbcast:15 row_mask:0xf bank_mask:0xf
    v_perm_b32 v60, v29, v29, v8
    v_perm_b32 v61, v29, v29, v9
    v_perm_b32 v62, v29, v29, v10
    v_perm_b32 v63, v29, v29, v11
    s_waitcnt vmcnt(3)
    buffer_load_dwordx4 v[72:75], v1, s[48:51], s52 offen offset:512 nt
    v_mfma_f32_16x16x32_bf16 v[16:19], v[120:123], v[56:59], v[16:19]
    v_mov_b32_dpp v28, v21 row_newbcast:0 row_mask:0xf bank_mask:0xf
    v_perm_b32 v48, v28, v28, v8
    v_perm_b32 v49, v28, v28, v9
    v_perm_b32 v50, v28, v28, v10
    v_perm_b32 v51, v28, v28, v11
    s_waitcnt vmcnt(4)
    s_cmp_ge_u32 s75, 3
    s_cbranch_scc1 L_d80
    s_waitcnt vmcnt(2)
    s_cmp_gt_u32 s75, 1
    s_cbranch_scc1 L_d80
    s_waitcnt vmcnt(1)
L_d80:
    buffer_load_dwordx4 v[76:79], v1, s[48:51], s52 offen offset:768 nt
    s_cmp_lg_u32 s3, 0
    s_cbranch_scc1 L_a81
    v_readlane_b32 s83, v240, 8
    s_mov_b32 s43, 1
    s_nop 3
    s_and_b32 s83, s83, 0xfff80
    s_atomic_add s43, s[76:77], s83 glc
L_a81:
    v_mfma_f32_16x16x32_bf16 v[16:19], v[124:127], v[60:63], v[16:19]
    v_mov_b32_dpp v29, v21 row_newbcast:1 row_mask:0xf bank_mask:0xf
    v_perm_b32 v52, v29, v29, v8
    v_perm_b32 v53, v29, v29, v9
    v_perm_b32 v54, v29, v29, v10
    v_perm_b32 v55, v29, v29, v11
    s_waitcnt vmcnt(2)
    buffer_load_dwordx4 v[80:83], v1, s[48:51], s52 offen offset:1024 nt
    s_add_u32 s38, s46, 16384
    buffer_load_dwordx4 v[144:147], v3, s[24:27], s38 offen offset:0
    v_mfma_f32_16x16x32_bf16 v[12:15], v[64:67], v[48:51], v[12:15]
    v_mov_b32_dpp v28, v21 row_newbcast:2 row_mask:0xf bank_mask:0xf
    v_perm_b32 v56, v28, v28, v8
    v_perm_b32 v57, v28, v28, v9
    v_perm_b32 v58, v28, v28, v10
    v_perm_b32 v59, v28, v28, v11
    s_waitcnt vmcnt(4)
    s_cmp_ge_u32 s75, 4
    s_cbranch_scc1 L_d82
    s_waitcnt vmcnt(3)
    s_cmp_gt_u32 s75, 0
    s_cbranch_scc1 L_d82
    s_waitcnt vmcnt(2)
L_d82:
    buffer_load_dwordx4 v[84:87], v1, s[48:51], s52 offen offset:1280 nt
    v_mfma_f32_16x16x32_bf16 v[12:15], v[68:71], v[52:55], v[12:15]
    v_mov_b32_dpp v29, v21 row_newbcast:3 row_mask:0xf bank_mask:0xf
    v_perm_b32 v60, v29, v29, v8
    v_perm_b32 v61, v29, v29, v9
    v_perm_b32 v62, v29, v29, v10
    v_perm_b32 v63, v29, v29, v11
    s_waitcnt vmcnt(3)
    buffer_load_dwordx4 v[88:91], v1, s[48:51], s52 offen offset:1536 nt
    v_mfma_f32_16x16x32_bf16 v[12:15], v[72:75], v[56:59], v[12:15]
    v_mov_b32_dpp v28, v21 row_newbcast:4 row_mask:0xf bank_mask:0xf
    v_perm_b32 v48, v28, v28, v8
    v_perm_b32 v49, v28, v28, v9
    v_perm_b32 v50, v28, v28, v10
    v_perm_b32 v51, v28, v28, v11
    s_waitcnt vmcnt(4)
    s_cmp_ge_u32 s75, 3
    s_cbranch_scc1 L_d83
    s_waitcnt vmcnt(3)
    s_cmp_gt_u32 s75, 1
    s_cbranch_scc1 L_d83
    s_waitcnt vmcnt(1)
L_d83:
    buffer_load_dwordx4 v[92:95], v1, s[48:51], s52 offen offset:1792 nt
    v_mfma_f32_16x16x32_bf16 v[12:15], v[76:79], v[60:63], v[12:15]
    v_mov_b32_dpp v29, v21 row_newbcast:5 row_mask:0xf bank_mask:0xf
    v_perm_b32 v52, v29, v29, v8
    v_perm_b32 v53, v29, v29, v9
    v_perm_b32 v54, v29, v29, v10
    v_perm_b32 v55, v29, v29, v11
    s_waitcnt vmcnt(2)
    buffer_load_dwordx4 v[96:99], v1, s[48:51], s53 offen offset:0 nt
    s_add_u32 s38, s46, 20480
    buffer_load_dwordx4 v[148:151], v3, s[24:27], s38 offen offset:0
    v_mfma_f32_16x16x32_bf16 v[12:15], v[80:83], v[48:51], v[12:15]
    v_mov_b32_dpp v28, v21 row_newbcast:6 row_mask:0xf bank_mask:0xf
    v_perm_b32 v56, v28, v28, v8
    v_perm_b32 v57, v28, v28, v9
    v_perm_b32 v58, v28, v28, v10
    v_perm_b32 v59, v28, v28, v11
    s_waitcnt vmcnt(4)
    s_cmp_ge_u32 s75, 4
    s_cbranch_scc1 L_d84
    s_waitcnt vmcnt(3)
    s_cmp_gt_u32 s75, 0
    s_cbranch_scc1 L_d84
    s_waitcnt vmcnt(2)
L_d84:
    buffer_load_dwordx4 v[100:103], v1, s[48:51], s53 offen offset:256 nt
    v_readlane_b32 s82, v241, 8
    s_waitcnt lgkmcnt(0)
    s_sub_u32 s43, s43, s82
    s_min_u32 s43, s43, 3
    s_lshl_b32 s43, s43, 2
    s_lshr_b32 s43, 0x3221, s43
    s_and_b32 s43, s43, 7
    v_mov_b32 v243, s43
    s_cmp_lg_u32 s3, 0
    s_cbranch_scc1 L_w85
    ds_write_b32 v244, v243 offset:11264
L_w85:
    v_mfma_f32_16x16x32_bf16 v[12:15], v[84:87], v[52:55], v[12:15]
    v_mov_b32_dpp v29, v21 row_newbcast:7 row_mask:0xf bank_mask:0xf
    v_perm_b32 v60, v29, v29, v8
    v_perm_b32 v61, v29, v29, v9
    v_perm_b32 v62, v29, v29, v10
    v_perm_b32 v63, v29, v29, v11
    s_waitcnt vmcnt(3)
    buffer_load_dwordx4 v[104:107], v1, s[48:51], s53 offen offset:512 nt
    v_mfma_f32_16x16x32_bf16 v[12:15], v[88:91], v[56:59], v[12:15]
    v_mov_b32_dpp v28, v21 row_newbcast:8 row_mask:0xf bank_mask:0xf
    v_perm_b32 v48, v28, v28, v8
    v_perm_b32 v49, v28, v28, v9
    v_perm_b32 v50, v28, v28, v10
    v_perm_b32 v51, v28, v28, v11
    s_waitcnt vmcnt(4)
    s_cmp_ge_u32 s75, 3
    s_cbranch_scc1 L_d86
    s_waitcnt vmcnt(3)
    s_cmp_gt_u32 s75, 1
    s_cbranch_scc1 L_d86
    s_waitcnt vmcnt(1)
L_d86:
    buffer_load_dwordx4 v[108:111], v1, s[48:51], s53 offen offset:768 nt
    v_mfma_f32_16x16x32_bf16 v[12:15], v[92:95], v[60:63], v[12:15]
    v_mov_b32_dpp v29, v21 row_newbcast:9 row_mask:0xf bank_mask:0xf
    v_perm_b32 v52, v29, v29, v8
    v_perm_b32 v53, v29, v29, v9
    v_perm_b32 v54, v29, v29, v10
    v_perm_b32 v55, v29, v29, v11
    s_waitcnt vmcnt(2)
    buffer_load_dwordx4 v[112:115], v1, s[48:51], s53 offen offset:1024 nt
    s_add_u32 s38, s46, 24576
    buffer_load_dwordx4 v[152:155], v3, s[24:27], s38 offen offset:0
    ds_read_b32 v243, v244 offset:11264
    v_mfma_f32_16x16x32_bf16 v[16:19], v[96:99], v[48:51], v[16:19]
    v_mov_b32_dpp v28, v21 row_newbcast:10 row_mask:0xf bank_mask:0xf
    v_perm_b32 v56, v28, v28, v8
    v_perm_b32 v57, v28, v28, v9
    v_perm_b32 v58, v28, v28, v10
    v_perm_b32 v59, v28, v28, v11
    s_waitcnt vmcnt(4)
    s_cmp_ge_u32 s75, 4
    s_cbranch_scc1 L_d87
    s_waitcnt vmcnt(3)
    s_cmp_gt_u32 s75, 0
    s_cbranch_scc1 L_d87
    s_waitcnt vmcnt(2)
L_d87:
    buffer_load_dwordx4 v[116:119], v1, s[48:51], s53 offen offset:1280 nt
    s_waitcnt lgkmcnt(0)
    v_readfirstlane_b32 s75, v243
    s_nop 0
    v_mfma_f32_16x16x32_bf16 v[16:19], v[100:103], v[52:55], v[16:19]
    v_mov_b32_dpp v29, v21 row_newbcast:11 row_mask:0xf bank_mask:0xf
    v_perm_b32 v60, v29, v29, v8
    v_perm_b32 v61, v29, v29, v9
    v_perm_b32 v62, v29, v29, v10
    v_perm_b32 v63, v29, v29, v11
    s_waitcnt vmcnt(3)
    buffer_load_dwordx4 v[120:123], v1, s[48:51], s53 offen offset:1536 nt
    v_mfma_f32_16x16x32_bf16 v[16:19], v[104:107], v[56:59], v[16:19]
    v_mov_b32_dpp v28, v21 row_newbcast:12 row_mask:0xf bank_mask:0xf
    v_perm_b32 v48, v28, v28, v8
    v_perm_b32 v49, v28, v28, v9
    v_perm_b32 v50, v28, v28, v10
    v_perm_b32 v51, v28, v28, v11
    s_waitcnt vmcnt(4)
    s_cmp_ge_u32 s75, 3
    s_cbranch_scc1 L_d88
    s_waitcnt vmcnt(3)
    s_cmp_gt_u32 s75, 1
    s_cbranch_scc1 L_d88
    s_waitcnt vmcnt(1)
L_d88:
    buffer_load_dwordx4 v[124:127], v1, s[48:51], s53 offen offset:1792 nt
    s_add_u32 s38, s46, 28672
    buffer_load_dwordx4 v[156:159], v3, s[24:27], s38 offen offset:0
    v_mfma_f32_16x16x32_bf16 v[16:19], v[108:111], v[60:63], v[16:19]
    v_mov_b32_dpp v29, v21 row_newbcast:13 row_mask:0xf bank_mask:0xf
    v_perm_b32 v52, v29, v29, v8
    v_perm_b32 v53, v29, v29, v9
    v_perm_b32 v54, v29, v29, v10
    v_perm_b32 v55, v29, v29, v11
    s_waitcnt vmcnt(3)
    s_xor_b32 s34, s32, 131072
    s_add_u32 s35, s34, 0x80000
    buffer_load_dwordx4 v[64:67], v1, s[48:51], s34 offen offset:0 nt
    v_mfma_f32_16x16x32_bf16 v[16:19], v[112:115], v[48:51], v[16:19]
    v_mov_b32_dpp v28, v21 row_newbcast:14 row_mask:0xf bank_mask:0xf
    v_perm_b32 v56, v28, v28, v8
    v_perm_b32 v57, v28, v28, v9
    v_perm_b32 v58, v28, v28, v10
    v_perm_b32 v59, v28, v28, v11
    s_waitcnt vmcnt(4)
    s_cmp_ge_u32 s75, 4
    s_cbranch_scc1 L_d89
    s_waitcnt vmcnt(3)
    s_cmp_gt_u32 s75, 0
    s_cbranch_scc1 L_d89
    s_waitcnt vmcnt(2)
L_d89:
    buffer_load_dwordx4 v[68:71], v1, s[48:51], s34 offen offset:256 nt
    v_mfma_f32_16x16x32_bf16 v[16:19], v[116:119], v[52:55], v[16:19]
    v_mov_b32_dpp v29, v21 row_newbcast:15 row_mask:0xf bank_mask:0xf
    v_perm_b32 v60, v29, v29, v8
    v_perm_b32 v61, v29, v29, v9
    v_perm_b32 v62, v29, v29, v10
    v_perm_b32 v63, v29, v29, v11
    s_waitcnt vmcnt(3)
    buffer_load_dwordx4 v[72:75], v1, s[48:51], s34 offen offset:512 nt
    v_mfma_f32_16x16x32_bf16 v[16:19], v[120:123], v[56:59], v[16:19]
    v_mov_b32_dpp v28, v22 row_newbcast:0 row_mask:0xf bank_mask:0xf
    v_perm_b32 v48, v28, v28, v8
    v_perm_b32 v49, v28, v28, v9
    v_perm_b32 v50, v28, v28, v10
    v_perm_b32 v51, v28, v28, v11
    s_waitcnt vmcnt(4)
    s_cmp_ge_u32 s75, 3
    s_cbranch_scc1 L_d90
    s_waitcnt vmcnt(2)
    s_cmp_gt_u32 s75, 1
    s_cbranch_scc1 L_d90
    s_waitcnt vmcnt(1)
L_d90:
    buffer_load_dwordx4 v[76:79], v1, s[48:51], s34 offen offset:768 nt
    s_cmp_lg_u32 s3, 0
    s_cbranch_scc1 L_a91
    v_readlane_b32 s83, v240, 9
    s_mov_b32 s43, 1
    s_nop 3
    s_and_b32 s83, s83, 0xfff80
    s_atomic_add s43, s[76:77], s83 glc
L_a91:
    v_mfma_f32_16x16x32_bf16 v[16:19], v[124:127], v[60:63], v[16:19]
    v_mov_b32_dpp v29, v22 row_newbcast:1 row_mask:0xf bank_mask:0xf
    v_perm_b32 v52, v29, v29, v8
    v_perm_b32 v53, v29, v29, v9
    v_perm_b32 v54, v29, v29, v10
    v_perm_b32 v55, v29, v29, v11
    s_waitcnt vmcnt(2)
    buffer_load_dwordx4 v[80:83], v1, s[48:51], s34 offen offset:1024 nt
    s_add_u32 s38, s46, 32768
    buffer_load_dwordx4 v[160:163], v3, s[24:27], s38 offen offset:0
    v_mfma_f32_16x16x32_bf16 v[12:15], v[64:67], v[48:51], v[12:15]
    v_mov_b32_dpp v28, v22 row_newbcast:2 row_mask:0xf bank_mask:0xf
    v_perm_b32 v56, v28, v28, v8
    v_perm_b32 v57, v28, v28, v9
    v_perm_b32 v58, v28, v28, v10
    v_perm_b32 v59, v28, v28, v11
    s_waitcnt vmcnt(4)
    s_cmp_ge_u32 s75, 4
    s_cbranch_scc1 L_d92
    s_waitcnt vmcnt(3)
    s_cmp_gt_u32 s75, 0
    s_cbranch_scc1 L_d92
    s_waitcnt vmcnt(2)
L_d92:
    buffer_load_dwordx4 v[84:87], v1, s[48:51], s34 offen offset:1280 nt
    v_mfma_f32_16x16x32_bf16 v[12:15], v[68:71], v[52:55], v[12:15]
    v_mov_b32_dpp v29, v22 row_newbcast:3 row_mask:0xf bank_mask:0xf
    v_perm_b32 v60, v29, v29, v8
    v_perm_b32 v61, v29, v29, v9
    v_perm_b32 v62, v29, v29, v10
    v_perm_b32 v63, v29, v29, v11
    s_waitcnt vmcnt(3)
    buffer_load_dwordx4 v[88:91], v1, s[48:51], s34 offen offset:1536 nt
    v_mfma_f32_16x16x32_bf16 v[12:15], v[72:75], v[56:59], v[12:15]
    v_mov_b32_dpp v28, v22 row_newbcast:4 row_mask:0xf bank_mask:0xf
    v_perm_b32 v48, v28, v28, v8
    v_perm_b32 v49, v28, v28, v9
    v_perm_b32 v50, v28, v28, v10
    v_perm_b32 v51, v28, v28, v11
    s_waitcnt vmcnt(4)
    s_cmp_ge_u32 s75, 3
    s_cbranch_scc1 L_d93
    s_waitcnt vmcnt(3)
    s_cmp_gt_u32 s75, 1
    s_cbranch_scc1 L_d93
    s_waitcnt vmcnt(1)
L_d93:
    buffer_load_dwordx4 v[92:95], v1, s[48:51], s34 offen offset:1792 nt
    v_mfma_f32_16x16x32_bf16 v[12:15], v[76:79], v[60:63], v[12:15]
    v_mov_b32_dpp v29, v22 row_newbcast:5 row_mask:0xf bank_mask:0xf
    v_perm_b32 v52, v29, v29, v8
    v_perm_b32 v53, v29, v29, v9
    v_perm_b32 v54, v29, v29, v10
    v_perm_b32 v55, v29, v29, v11
    s_waitcnt vmcnt(2)
    buffer_load_dwordx4 v[96:99], v1, s[48:51], s35 offen offset:0 nt
    s_add_u32 s38, s46, 36864
    buffer_load_dwordx4 v[164:167], v3, s[24:27], s38 offen offset:0
    v_mfma_f32_16x16x32_bf16 v[12:15], v[80:83], v[48:51], v[12:15]
    v_mov_b32_dpp v28, v22 row_newbcast:6 row_mask:0xf bank_mask:0xf
    v_perm_b32 v56, v28, v28, v8
    v_perm_b32 v57, v28, v28, v9
    v_perm_b32 v58, v28, v28, v10
    v_perm_b32 v59, v28, v28, v11
    s_waitcnt vmcnt(4)
    s_cmp_ge_u32 s75, 4
    s_cbranch_scc1 L_d94
    s_waitcnt vmcnt(3)
    s_cmp_gt_u32 s75, 0
    s_cbranch_scc1 L_d94
    s_waitcnt vmcnt(2)
L_d94:
    buffer_load_dwordx4 v[100:103], v1, s[48:51], s35 offen offset:256 nt
    v_readlane_b32 s82, v241, 9
    s_waitcnt lgkmcnt(0)
    s_sub_u32 s43, s43, s82
    s_min_u32 s43, s43, 3
    s_lshl_b32 s43, s43, 2
    s_lshr_b32 s43, 0x3221, s43
    s_and_b32 s43, s43, 7
    v_mov_b32 v243, s43
    s_cmp_lg_u32 s3, 0
    s_cbranch_scc1 L_w95
    ds_write_b32 v244, v243 offset:11264
L_w95:
    v_mfma_f32_16x16x32_bf16 v[12:15], v[84:87], v[52:55], v[12:15]
    v_mov_b32_dpp v29, v22 row_newbcast:7 row_mask:0xf bank_mask:0xf
    v_perm_b32 v60, v29, v29, v8
    v_perm_b32 v61, v29, v29, v9
    v_perm_b32 v62, v29, v29, v10
    v_perm_b32 v63, v29, v29, v11
    s_waitcnt vmcnt(3)
    buffer_load_dwordx4 v[104:107], v1, s[48:51], s35 offen offset:512 nt
    v_mfma_f32_16x16x32_bf16 v[12:15], v[88:91], v[56:59], v[12:15]
    v_mov_b32_dpp v28, v22 row_newbcast:8 row_mask:0xf bank_mask:0xf
    v_perm_b32 v48, v28, v28, v8
    v_perm_b32 v49, v28, v28, v9
    v_perm_b32 v50, v28, v28, v10
    v_perm_b32 v51, v28, v28, v11
    s_waitcnt vmcnt(4)
    s_cmp_ge_u32 s75, 3
    s_cbranch_scc1 L_d96
    s_waitcnt vmcnt(3)
    s_cmp_gt_u32 s75, 1
    s_cbranch_scc1 L_d96
    s_waitcnt vmcnt(1)
L_d96:
    buffer_load_dwordx4 v[108:111], v1, s[48:51], s35 offen offset:768 nt
    v_mfma_f32_16x16x32_bf16 v[12:15], v[92:95], v[60:63], v[12:15]
    v_mov_b32_dpp v29, v22 row_newbcast:9 row_mask:0xf bank_mask:0xf
    v_perm_b32 v52, v29, v29, v8
    v_perm_b32 v53, v29, v29, v9
    v_perm_b32 v54, v29, v29, v10
    v_perm_b32 v55, v29, v29, v11
    s_waitcnt vmcnt(2)
    buffer_load_dwordx4 v[112:115], v1, s[48:51], s35 offen offset:1024 nt
    s_add_u32 s38, s46, 40960
    buffer_load_dwordx4 v[168:171], v3, s[24:27], s38 offen offset:0
    ds_read_b32 v243, v244 offset:11264
    v_mfma_f32_16x16x32_bf16 v[16:19], v[96:99], v[48:51], v[16:19]
    v_mov_b32_dpp v28, v22 row_newbcast:10 row_mask:0xf bank_mask:0xf
    v_perm_b32 v56, v28, v28, v8
    v_perm_b32 v57, v28, v28, v9
    v_perm_b32 v58, v28, v28, v10
    v_perm_b32 v59, v28, v28, v11
    s_waitcnt vmcnt(4)
    s_cmp_ge_u32 s75, 4
    s_cbranch_scc1 L_d97
    s_waitcnt vmcnt(3)
    s_cmp_gt_u32 s75, 0
    s_cbranch_scc1 L_d97
    s_waitcnt vmcnt(2)
L_d97:
    buffer_load_dwordx4 v[116:119], v1, s[48:51], s35 offen offset:1280 nt
    s_waitcnt lgkmcnt(0)
    v_readfirstlane_b32 s75, v243
    s_nop 0
    v_mfma_f32_16x16x32_bf16 v[16:19], v[100:103], v[52:55], v[16:19]
    v_mov_b32_dpp v29, v22 row_newbcast:11 row_mask:0xf bank_mask:0xf
    v_perm_b32 v60, v29, v29, v8
    v_perm_b32 v61, v29, v29, v9
    v_perm_b32 v62, v29, v29, v10
    v_perm_b32 v63, v29, v29, v11
    s_waitcnt vmcnt(3)
    buffer_load_dwordx4 v[120:123], v1, s[48:51], s35 offen offset:1536 nt
    v_mfma_f32_16x16x32_bf16 v[16:19], v[104:107], v[56:59], v[16:19]
    v_mov_b32_dpp v28, v22 row_newbcast:12 row_mask:0xf bank_mask:0xf
    v_perm_b32 v48, v28, v28, v8
    v_perm_b32 v49, v28, v28, v9
    v_perm_b32 v50, v28, v28, v10
    v_perm_b32 v51, v28, v28, v11
    s_waitcnt vmcnt(4)
    s_cmp_ge_u32 s75, 3
    s_cbranch_scc1 L_d98
    s_waitcnt vmcnt(3)
    s_cmp_gt_u32 s75, 1
    s_cbranch_scc1 L_d98
    s_waitcnt vmcnt(1)
L_d98:
    buffer_load_dwordx4 v[124:127], v1, s[48:51], s35 offen offset:1792 nt
    s_add_u32 s38, s46, 45056
    buffer_load_dwordx4 v[172:175], v3, s[24:27], s38 offen offset:0
    v_mfma_f32_16x16x32_bf16 v[16:19], v[108:111], v[60:63], v[16:19]
    v_mov_b32_dpp v29, v22 row_newbcast:13 row_mask:0xf bank_mask:0xf
    v_perm_b32 v52, v29, v29, v8
    v_perm_b32 v53, v29, v29, v9
    v_perm_b32 v54, v29, v29, v10
    v_perm_b32 v55, v29, v29, v11
    s_waitcnt vmcnt(3)
    s_xor_b32 s52, s33, 131072
    s_add_u32 s53, s52, 0x80000
    buffer_load_dwordx4 v[64:67], v1, s[48:51], s52 offen offset:0 nt
    v_mfma_f32_16x16x32_bf16 v[16:19], v[112:115], v[48:51], v[16:19]
    v_mov_b32_dpp v28, v22 row_newbcast:14 row_mask:0xf bank_mask:0xf
    v_perm_b32 v56, v28, v28, v8
    v_perm_b32 v57, v28, v28, v9
    v_perm_b32 v58, v28, v28, v10
    v_perm_b32 v59, v28, v28, v11
    s_waitcnt vmcnt(4)
    s_cmp_ge_u32 s75, 4
    s_cbranch_scc1 L_d99
    s_waitcnt vmcnt(3)
    s_cmp_gt_u32 s75, 0
    s_cbranch_scc1 L_d99
    s_waitcnt vmcnt(2)
L_d99:
    buffer_load_dwordx4 v[68:71], v1, s[48:51], s52 offen offset:256 nt
    v_mfma_f32_16x16x32_bf16 v[16:19], v[116:119], v[52:55], v[16:19]
    v_mov_b32_dpp v29, v22 row_newbcast:15 row_mask:0xf bank_mask:0xf
    v_perm_b32 v60, v29, v29, v8
    v_perm_b32 v61, v29, v29, v9
    v_perm_b32 v62, v29, v29, v10
    v_perm_b32 v63, v29, v29, v11
    s_waitcnt vmcnt(3)
    buffer_load_dwordx4 v[72:75], v1, s[48:51], s52 offen offset:512 nt
    v_mfma_f32_16x16x32_bf16 v[16:19], v[120:123], v[56:59], v[16:19]
    v_mov_b32_dpp v28, v23 row_newbcast:0 row_mask:0xf bank_mask:0xf
    v_perm_b32 v48, v28, v28, v8
    v_perm_b32 v49, v28, v28, v9
    v_perm_b32 v50, v28, v28, v10
    v_perm_b32 v51, v28, v28, v11
    s_waitcnt vmcnt(4)
    s_cmp_ge_u32 s75, 3
    s_cbranch_scc1 L_d100
    s_waitcnt vmcnt(2)
    s_cmp_gt_u32 s75, 1
    s_cbranch_scc1 L_d100
    s_waitcnt vmcnt(1)
L_d100:
    buffer_load_dwordx4 v[76:79], v1, s[48:51], s52 offen offset:768 nt
    s_cmp_lg_u32 s3, 0
    s_cbranch_scc1 L_a101
    v_readlane_b32 s83, v240, 10
    s_mov_b32 s43, 1
    s_nop 3
    s_and_b32 s83, s83, 0xfff80
    s_atomic_add s43, s[76:77], s83 glc
L_a101:
    v_mfma_f32_16x16x32_bf16 v[16:19], v[124:127], v[60:63], v[16:19]
    v_mov_b32_dpp v29, v23 row_newbcast:1 row_mask:0xf bank_mask:0xf
    v_perm_b32 v52, v29, v29, v8
    v_perm_b32 v53, v29, v29, v9
    v_perm_b32 v54, v29, v29, v10
    v_perm_b32 v55, v29, v29, v11
    s_waitcnt vmcnt(2)
    buffer_load_dwordx4 v[80:83], v1, s[48:51], s52 offen offset:1024 nt
    s_add_u32 s38, s46, 49152
    buffer_load_dwordx4 v[176:179], v3, s[24:27], s38 offen offset:0
    v_mfma_f32_16x16x32_bf16 v[12:15], v[64:67], v[48:51], v[12:15]
    v_mov_b32_dpp v28, v23 row_newbcast:2 row_mask:0xf bank_mask:0xf
    v_perm_b32 v56, v28, v28, v8
    v_perm_b32 v57, v28, v28, v9
    v_perm_b32 v58, v28, v28, v10
    v_perm_b32 v59, v28, v28, v11
    s_waitcnt vmcnt(4)
    s_cmp_ge_u32 s75, 4
    s_cbranch_scc1 L_d102
    s_waitcnt vmcnt(3)
    s_cmp_gt_u32 s75, 0
    s_cbranch_scc1 L_d102
    s_waitcnt vmcnt(2)
L_d102:
    buffer_load_dwordx4 v[84:87], v1, s[48:51], s52 offen offset:1280 nt
    v_mfma_f32_16x16x32_bf16 v[12:15], v[68:71], v[52:55], v[12:15]
    v_mov_b32_dpp v29, v23 row_newbcast:3 row_mask:0xf bank_mask:0xf
    v_perm_b32 v60, v29, v29, v8
    v_perm_b32 v61, v29, v29, v9
    v_perm_b32 v62, v29, v29, v10
    v_perm_b32 v63, v29, v29, v11
    s_waitcnt vmcnt(3)
    buffer_load_dwordx4 v[88:91], v1, s[48:51], s52 offen offset:1536 nt
    v_mfma_f32_16x16x32_bf16 v[12:15], v[72:75], v[56:59], v[12:15]
    v_mov_b32_dpp v28, v23 row_newbcast:4 row_mask:0xf bank_mask:0xf
    v_perm_b32 v48, v28, v28, v8
    v_perm_b32 v49, v28, v28, v9
    v_perm_b32 v50, v28, v28, v10
    v_perm_b32 v51, v28, v28, v11
    s_waitcnt vmcnt(4)
    s_cmp_ge_u32 s75, 3
    s_cbranch_scc1 L_d103
    s_waitcnt vmcnt(3)
    s_cmp_gt_u32 s75, 1
    s_cbranch_scc1 L_d103
    s_waitcnt vmcnt(1)
L_d103:
    buffer_load_dwordx4 v[92:95], v1, s[48:51], s52 offen offset:1792 nt
    v_mfma_f32_16x16x32_bf16 v[12:15], v[76:79], v[60:63], v[12:15]
    v_mov_b32_dpp v29, v23 row_newbcast:5 row_mask:0xf bank_mask:0xf
    v_perm_b32 v52, v29, v29, v8
    v_perm_b32 v53, v29, v29, v9
    v_perm_b32 v54, v29, v29, v10
    v_perm_b32 v55, v29, v29, v11
    s_waitcnt vmcnt(2)
    buffer_load_dwordx4 v[96:99], v1, s[48:51], s53 offen offset:0 nt
    s_add_u32 s38, s46, 53248
    buffer_load_dwordx4 v[180:183], v3, s[24:27], s38 offen offset:0
    v_mfma_f32_16x16x32_bf16 v[12:15], v[80:83], v[48:51], v[12:15]
    v_mov_b32_dpp v28, v23 row_newbcast:6 row_mask:0xf bank_mask:0xf
    v_perm_b32 v56, v28, v28, v8
    v_perm_b32 v57, v28, v28, v9
    v_perm_b32 v58, v28, v28, v10
    v_perm_b32 v59, v28, v28, v11
    s_waitcnt vmcnt(4)
    s_cmp_ge_u32 s75, 4
    s_cbranch_scc1 L_d104
    s_waitcnt vmcnt(3)
    s_cmp_gt_u32 s75, 0
    s_cbranch_scc1 L_d104
    s_waitcnt vmcnt(2)
L_d104:
    buffer_load_dwordx4 v[100:103], v1, s[48:51], s53 offen offset:256 nt
    v_readlane_b32 s82, v241, 10
    s_waitcnt lgkmcnt(0)
    s_sub_u32 s43, s43, s82
    s_min_u32 s43, s43, 3
    s_lshl_b32 s43, s43, 2
    s_lshr_b32 s43, 0x3221, s43
    s_and_b32 s43, s43, 7
    v_mov_b32 v243, s43
    s_cmp_lg_u32 s3, 0
    s_cbranch_scc1 L_w105
    ds_write_b32 v244, v243 offset:11264
L_w105:
    v_mfma_f32_16x16x32_bf16 v[12:15], v[84:87], v[52:55], v[12:15]
    v_mov_b32_dpp v29, v23 row_newbcast:7 row_mask:0xf bank_mask:0xf
    v_perm_b32 v60, v29, v29, v8
    v_perm_b32 v61, v29, v29, v9
    v_perm_b32 v62, v29, v29, v10
    v_perm_b32 v63, v29, v29, v11
    s_waitcnt vmcnt(3)
    buffer_load_dwordx4 v[104:107], v1, s[48:51], s53 offen offset:512 nt
    v_mfma_f32_16x16x32_bf16 v[12:15], v[88:91], v[56:59], v[12:15]
    v_mov_b32_dpp v28, v23 row_newbcast:8 row_mask:0xf bank_mask:0xf
    v_perm_b32 v48, v28, v28, v8
    v_perm_b32 v49, v28, v28, v9
    v_perm_b32 v50, v28, v28, v10
    v_perm_b32 v51, v28, v28, v11
    s_waitcnt vmcnt(4)
    s_cmp_ge_u32 s75, 3
    s_cbranch_scc1 L_d106
    s_waitcnt vmcnt(3)
    s_cmp_gt_u32 s75, 1
    s_cbranch_scc1 L_d106
    s_waitcnt vmcnt(1)
L_d106:
    buffer_load_dwordx4 v[108:111], v1, s[48:51], s53 offen offset:768 nt
    v_mfma_f32_16x16x32_bf16 v[12:15], v[92:95], v[60:63], v[12:15]
    v_mov_b32_dpp v29, v23 row_newbcast:9 row_mask:0xf bank_mask:0xf
    v_perm_b32 v52, v29, v29, v8
    v_perm_b32 v53, v29, v29, v9
    v_perm_b32 v54, v29, v29, v10
    v_perm_b32 v55, v29, v29, v11
    s_waitcnt vmcnt(2)
    buffer_load_dwordx4 v[112:115], v1, s[48:51], s53 offen offset:1024 nt
    s_add_u32 s38, s46, 57344
    buffer_load_dwordx4 v[184:187], v3, s[24:27], s38 offen offset:0
    ds_read_b32 v243, v244 offset:11264
    v_mfma_f32_16x16x32_bf16 v[16:19], v[96:99], v[48:51], v[16:19]
    v_mov_b32_dpp v28, v23 row_newbcast:10 row_mask:0xf bank_mask:0xf
    v_perm_b32 v56, v28, v28, v8
    v_perm_b32 v57, v28, v28, v9
    v_perm_b32 v58, v28, v28, v10
    v_perm_b32 v59, v28, v28, v11
    s_waitcnt vmcnt(4)
    s_cmp_ge_u32 s75, 4
    s_cbranch_scc1 L_d107
    s_waitcnt vmcnt(3)
    s_cmp_gt_u32 s75, 0
    s_cbranch_scc1 L_d107
    s_waitcnt vmcnt(2)
L_d107:
    buffer_load_dwordx4 v[116:119], v1, s[48:51], s53 offen offset:1280 nt
    s_waitcnt lgkmcnt(0)
    v_readfirstlane_b32 s75, v243
    s_nop 0
    v_mfma_f32_16x16x32_bf16 v[16:19], v[100:103], v[52:55], v[16:19]
    v_mov_b32_dpp v29, v23 row_newbcast:11 row_mask:0xf bank_mask:0xf
    v_perm_b32 v60, v29, v29, v8
    v_perm_b32 v61, v29, v29, v9
    v_perm_b32 v62, v29, v29, v10
    v_perm_b32 v63, v29, v29, v11
    s_waitcnt vmcnt(3)
    buffer_load_dwordx4 v[120:123], v1, s[48:51], s53 offen offset:1536 nt
    v_mfma_f32_16x16x32_bf16 v[16:19], v[104:107], v[56:59], v[16:19]
    v_mov_b32_dpp v28, v23 row_newbcast:12 row_mask:0xf bank_mask:0xf
    v_perm_b32 v48, v28, v28, v8
    v_perm_b32 v49, v28, v28, v9
    v_perm_b32 v50, v28, v28, v10
    v_perm_b32 v51, v28, v28, v11
    s_waitcnt vmcnt(4)
    s_cmp_ge_u32 s75, 3
    s_cbranch_scc1 L_d108
    s_waitcnt vmcnt(3)
    s_cmp_gt_u32 s75, 1
    s_cbranch_scc1 L_d108
    s_waitcnt vmcnt(1)
L_d108:
    buffer_load_dwordx4 v[124:127], v1, s[48:51], s53 offen offset:1792 nt
    s_add_u32 s38, s46, 61440
    buffer_load_dwordx4 v[188:191], v3, s[24:27], s38 offen offset:0
    v_mfma_f32_16x16x32_bf16 v[16:19], v[108:111], v[60:63], v[16:19]
    v_mov_b32_dpp v29, v23 row_newbcast:13 row_mask:0xf bank_mask:0xf
    v_perm_b32 v52, v29, v29, v8
    v_perm_b32 v53, v29, v29, v9
    v_perm_b32 v54, v29, v29, v10
    v_perm_b32 v55, v29, v29, v11
    s_waitcnt vmcnt(3)
    s_xor_b32 s34, s32, 262144
    s_add_u32 s35, s34, 0x80000
    buffer_load_dwordx4 v[64:67], v1, s[48:51], s34 offen offset:0 nt
    v_mfma_f32_16x16x32_bf16 v[16:19], v[112:115], v[48:51], v[16:19]
    v_mov_b32_dpp v28, v23 row_newbcast:14 row_mask:0xf bank_mask:0xf
    v_perm_b32 v56, v28, v28, v8
    v_perm_b32 v57, v28, v28, v9
    v_perm_b32 v58, v28, v28, v10
    v_perm_b32 v59, v28, v28, v11
    s_waitcnt vmcnt(4)
    s_cmp_ge_u32 s75, 4
    s_cbranch_scc1 L_d109
    s_waitcnt vmcnt(3)
    s_cmp_gt_u32 s75, 0
    s_cbranch_scc1 L_d109
    s_waitcnt vmcnt(2)
L_d109:
    buffer_load_dwordx4 v[68:71], v1, s[48:51], s34 offen offset:256 nt
    v_mfma_f32_16x16x32_bf16 v[16:19], v[116:119], v[52:55], v[16:19]
    v_mov_b32_dpp v29, v23 row_newbcast:15 row_mask:0xf bank_mask:0xf
    v_perm_b32 v60, v29, v29, v8
    v_perm_b32 v61, v29, v29, v9
    v_perm_b32 v62, v29, v29, v10
    v_perm_b32 v63, v29, v29, v11
    s_waitcnt vmcnt(3)
    buffer_load_dwordx4 v[72:75], v1, s[48:51], s34 offen offset:512 nt
    v_mfma_f32_16x16x32_bf16 v[16:19], v[120:123], v[56:59], v[16:19]
    buffer_load_dwordx4 v[76:79], v1, s[48:51], s34 offen offset:768 nt
    buffer_load_dwordx4 v[80:83], v1, s[48:51], s34 offen offset:1024 nt
    s_waitcnt vmcnt(5)
    v_perm_b32 v196, v32, v32, v8
    v_perm_b32 v197, v32, v32, v9
    v_perm_b32 v198, v32, v32, v10
    v_perm_b32 v199, v32, v32, v11
    v_perm_b32 v200, v33, v33, v8
    v_perm_b32 v201, v33, v33, v9
    v_perm_b32 v202, v33, v33, v10
    v_perm_b32 v203, v33, v33, v11
    v_mfma_f32_16x16x32_bf16 v[192:195], v[128:131], v[196:199], 0
    v_perm_b32 v204, v34, v34, v8
    v_perm_b32 v205, v34, v34, v9
    v_perm_b32 v206, v34, v34, v10
    v_perm_b32 v207, v34, v34, v11
    v_mfma_f32_16x16x32_bf16 v[192:195], v[132:135], v[200:203], v[192:195]
    v_perm_b32 v208, v35, v35, v8
    v_perm_b32 v209, v35, v35, v9
    v_perm_b32 v210, v35, v35, v10
    v_perm_b32 v211, v35, v35, v11
    v_mfma_f32_16x16x32_bf16 v[192:195], v[136:139], v[204:207], v[192:195]
    v_perm_b32 v196, v36, v36, v8
    v_perm_b32 v197, v36, v36, v9
    v_perm_b32 v198, v36, v36, v10
    v_perm_b32 v199, v36, v36, v11
    v_mfma_f32_16x16x32_bf16 v[192:195], v[140:143], v[208:211], v[192:195]
    v_perm_b32 v200, v37, v37, v8
    v_perm_b32 v201, v37, v37, v9
    v_perm_b32 v202, v37, v37, v10
    v_perm_b32 v203, v37, v37, v11
    v_mfma_f32_16x16x32_bf16 v[192:195], v[144:147], v[196:199], v[192:195]
    v_perm_b32 v204, v38, v38, v8
    v_perm_b32 v205, v38, v38, v9
    v_perm_b32 v206, v38, v38, v10
    v_perm_b32 v207, v38, v38, v11
    v_mfma_f32_16x16x32_bf16 v[192:195], v[148:151], v[200:203], v[192:195]
    v_perm_b32 v208, v39, v39, v8
    v_perm_b32 v209, v39, v39, v9
    v_perm_b32 v210, v39, v39, v10
    v_perm_b32 v211, v39, v39, v11
    v_mfma_f32_16x16x32_bf16 v[192:195], v[152:155], v[204:207], v[192:195]
    v_perm_b32 v196, v40, v40, v8
    v_perm_b32 v197, v40, v40, v9
    v_perm_b32 v198, v40, v40, v10
    v_perm_b32 v199, v40, v40, v11
    v_mfma_f32_16x16x32_bf16 v[192:195], v[156:159], v[208:211], v[192:195]
    v_perm_b32 v200, v41, v41, v8
    v_perm_b32 v201, v41, v41, v9
    v_perm_b32 v202, v41, v41, v10
    v_perm_b32 v203, v41, v41, v11
    v_mfma_f32_16x16x32_bf16 v[192:195], v[160:163], v[196:199], v[192:195]
    v_perm_b32 v204, v42, v42, v8
    v_perm_b32 v205, v42, v42, v9
    v_perm_b32 v206, v42, v42, v10
    v_perm_b32 v207, v42, v42, v11
    v_mfma_f32_16x16x32_bf16 v[192:195], v[164:167], v[200:203], v[192:195]
    v_perm_b32 v208, v43, v43, v8
    v_perm_b32 v209, v43, v43, v9
    v_perm_b32 v210, v43, v43, v10
    v_perm_b32 v211, v43, v43, v11
    v_mfma_f32_16x16x32_bf16 v[192:195], v[168:171], v[204:207], v[192:195]
    v_perm_b32 v196, v44, v44, v8
    v_perm_b32 v197, v44, v44, v9
    v_perm_b32 v198, v44, v44, v10
    v_perm_b32 v199, v44, v44, v11
    v_mfma_f32_16x16x32_bf16 v[192:195], v[172:175], v[208:211], v[192:195]
    v_perm_b32 v200, v45, v45, v8
    v_perm_b32 v201, v45, v45, v9
    v_perm_b32 v202, v45, v45, v10
    v_perm_b32 v203, v45, v45, v11
    v_mfma_f32_16x16x32_bf16 v[192:195], v[176:179], v[196:199], v[192:195]
    v_perm_b32 v204, v46, v46, v8
    v_perm_b32 v205, v46, v46, v9
    v_perm_b32 v206, v46, v46, v10
    v_perm_b32 v207, v46, v46, v11
    v_mfma_f32_16x16x32_bf16 v[192:195], v[180:183], v[200:203], v[192:195]
    v_perm_b32 v208, v47, v47, v8
    v_perm_b32 v209, v47, v47, v9
    v_perm_b32 v210, v47, v47, v10
    v_perm_b32 v211, v47, v47, v11
    v_mfma_f32_16x16x32_bf16 v[192:195], v[184:187], v[204:207], v[192:195]
    s_nop 0
    v_mfma_f32_16x16x32_bf16 v[192:195], v[188:191], v[208:211], v[192:195]
    s_nop 7
    v_permlane32_swap_b32 v192, v194
    v_permlane32_swap_b32 v193, v195
    s_nop 1
    v_permlane16_swap_b32 v192, v193
    v_permlane16_swap_b32 v194, v195
    v_and_b32 v24, s41, v192
    v_and_b32 v25, s41, v193
    v_and_b32 v26, s41, v194
    v_and_b32 v27, s41, v195
    v_sub_f32 v24, v192, v24
    v_sub_f32 v25, v193, v25
    v_sub_f32 v26, v194, v26
    v_sub_f32 v27, v195, v27
    v_perm_b32 v24, v192, v24, s40
    v_perm_b32 v25, v193, v25, s40
    v_perm_b32 v26, v194, v26, s40
    v_perm_b32 v27, v195, v27, s40
    v_mov_b32_dpp v28, v24 row_newbcast:0 row_mask:0xf bank_mask:0xf
    v_perm_b32 v48, v28, v28, v8
    v_perm_b32 v49, v28, v28, v9
    v_perm_b32 v50, v28, v28, v10
    v_perm_b32 v51, v28, v28, v11
    s_waitcnt vmcnt(6)
    s_cmp_lg_u32 s3, 0
    s_cbranch_scc1 L_a110
    v_readlane_b32 s83, v240, 11
    s_mov_b32 s43, 1
    s_nop 3
    s_and_b32 s83, s83, 0xfff80
    s_atomic_add s43, s[76:77], s83 glc
L_a110:
    v_mfma_f32_16x16x32_bf16 v[16:19], v[124:127], v[60:63], v[16:19]
    v_mov_b32_dpp v29, v24 row_newbcast:1 row_mask:0xf bank_mask:0xf
    v_perm_b32 v52, v29, v29, v8
    v_perm_b32 v53, v29, v29, v9
    v_perm_b32 v54, v29, v29, v10
    v_perm_b32 v55, v29, v29, v11
    s_waitcnt vmcnt(4)
    v_mfma_f32_16x16x32_bf16 v[12:15], v[64:67], v[48:51], v[12:15]
    v_mov_b32_dpp v28, v24 row_newbcast:2 row_mask:0xf bank_mask:0xf
    v_perm_b32 v56, v28, v28, v8
    v_perm_b32 v57, v28, v28, v9
    v_perm_b32 v58, v28, v28, v10
    v_perm_b32 v59, v28, v28, v11
    s_waitcnt vmcnt(3)
    s_cmp_ge_u32 s75, 4
    s_cbranch_scc1 L_d111
    s_waitcnt vmcnt(2)
    s_cmp_gt_u32 s75, 0
    s_cbranch_scc1 L_d111
    s_waitcnt vmcnt(1)
L_d111:
    buffer_load_dwordx4 v[84:87], v1, s[48:51], s34 offen offset:1280 nt
    v_mfma_f32_16x16x32_bf16 v[12:15], v[68:71], v[52:55], v[12:15]
    v_mov_b32_dpp v29, v24 row_newbcast:3 row_mask:0xf bank_mask:0xf
    v_perm_b32 v60, v29, v29, v8
    v_perm_b32 v61, v29, v29, v9
    v_perm_b32 v62, v29, v29, v10
    v_perm_b32 v63, v29, v29, v11
    s_waitcnt vmcnt(2)
    buffer_load_dwordx4 v[88:91], v1, s[48:51], s34 offen offset:1536 nt
    v_mfma_f32_16x16x32_bf16 v[12:15], v[72:75], v[56:59], v[12:15]
    v_mov_b32_dpp v28, v24 row_newbcast:4 row_mask:0xf bank_mask:0xf
    v_perm_b32 v48, v28, v28, v8
    v_perm_b32 v49, v28, v28, v9
    v_perm_b32 v50, v28, v28, v10
    v_perm_b32 v51, v28, v28, v11
    s_waitcnt vmcnt(3)
    s_cmp_ge_u32 s75, 3
    s_cbranch_scc1 L_d112
    s_waitcnt vmcnt(2)
    s_cmp_gt_u32 s75, 1
    s_cbranch_scc1 L_d112
    s_waitcnt vmcnt(1)
L_d112:
    buffer_load_dwordx4 v[92:95], v1, s[48:51], s34 offen offset:1792 nt
    v_mfma_f32_16x16x32_bf16 v[12:15], v[76:79], v[60:63], v[12:15]
    v_mov_b32_dpp v29, v24 row_newbcast:5 row_mask:0xf bank_mask:0xf
    v_perm_b32 v52, v29, v29, v8
    v_perm_b32 v53, v29, v29, v9
    v_perm_b32 v54, v29, v29, v10
    v_perm_b32 v55, v29, v29, v11
    s_waitcnt vmcnt(2)
    buffer_load_dwordx4 v[96:99], v1, s[48:51], s35 offen offset:0 nt
    v_mfma_f32_16x16x32_bf16 v[12:15], v[80:83], v[48:51], v[12:15]
    v_mov_b32_dpp v28, v24 row_newbcast:6 row_mask:0xf bank_mask:0xf
    v_perm_b32 v56, v28, v28, v8
    v_perm_b32 v57, v28, v28, v9
    v_perm_b32 v58, v28, v28, v10
    v_perm_b32 v59, v28, v28, v11
    s_waitcnt vmcnt(3)
    s_cmp_ge_u32 s75, 4
    s_cbranch_scc1 L_d113
    s_waitcnt vmcnt(2)
    s_cmp_gt_u32 s75, 0
    s_cbranch_scc1 L_d113
    s_waitcnt vmcnt(1)
L_d113:
    buffer_load_dwordx4 v[100:103], v1, s[48:51], s35 offen offset:256 nt
    v_readlane_b32 s82, v241, 11
    s_waitcnt lgkmcnt(0)
    s_sub_u32 s43, s43, s82
    s_min_u32 s43, s43, 3
    s_lshl_b32 s43, s43, 2
    s_lshr_b32 s43, 0x3221, s43
    s_and_b32 s43, s43, 7
    v_mov_b32 v243, s43
    s_cmp_lg_u32 s3, 0
    s_cbranch_scc1 L_w114
    ds_write_b32 v244, v243 offset:11264
L_w114:
    v_mfma_f32_16x16x32_bf16 v[12:15], v[84:87], v[52:55], v[12:15]
    v_mov_b32_dpp v29, v24 row_newbcast:7 row_mask:0xf bank_mask:0xf
    v_perm_b32 v60, v29, v29, v8
    v_perm_b32 v61, v29, v29, v9
    v_perm_b32 v62, v29, v29, v10
    v_perm_b32 v63, v29, v29, v11
    s_waitcnt vmcnt(2)
    buffer_load_dwordx4 v[104:107], v1, s[48:51], s35 offen offset:512 nt
    v_mfma_f32_16x16x32_bf16 v[12:15], v[88:91], v[56:59], v[12:15]
    v_mov_b32_dpp v28, v24 row_newbcast:8 row_mask:0xf bank_mask:0xf
    v_perm_b32 v48, v28, v28, v8
    v_perm_b32 v49, v28, v28, v9
    v_perm_b32 v50, v28, v28, v10
    v_perm_b32 v51, v28, v28, v11
    s_waitcnt vmcnt(3)
    s_cmp_ge_u32 s75, 3
    s_cbranch_scc1 L_d115
    s_waitcnt vmcnt(2)
    s_cmp_gt_u32 s75, 1
    s_cbranch_scc1 L_d115
    s_waitcnt vmcnt(1)
L_d115:
    buffer_load_dwordx4 v[108:111], v1, s[48:51], s35 offen offset:768 nt
    v_mfma_f32_16x16x32_bf16 v[12:15], v[92:95], v[60:63], v[12:15]
    v_mov_b32_dpp v29, v24 row_newbcast:9 row_mask:0xf bank_mask:0xf
    v_perm_b32 v52, v29, v29, v8
    v_perm_b32 v53, v29, v29, v9
    v_perm_b32 v54, v29, v29, v10
    v_perm_b32 v55, v29, v29, v11
    s_waitcnt vmcnt(2)
    buffer_load_dwordx4 v[112:115], v1, s[48:51], s35 offen offset:1024 nt
    ds_read_b32 v243, v244 offset:11264
    v_mfma_f32_16x16x32_bf16 v[16:19], v[96:99], v[48:51], v[16:19]
    v_mov_b32_dpp v28, v24 row_newbcast:10 row_mask:0xf bank_mask:0xf
    v_perm_b32 v56, v28, v28, v8
    v_perm_b32 v57, v28, v28, v9
    v_perm_b32 v58, v28, v28, v10
    v_perm_b32 v59, v28, v28, v11
    s_waitcnt vmcnt(3)
    s_cmp_ge_u32 s75, 4
    s_cbranch_scc1 L_d116
    s_waitcnt vmcnt(2)
    s_cmp_gt_u32 s75, 0
    s_cbranch_scc1 L_d116
    s_waitcnt vmcnt(1)
L_d116:
    buffer_load_dwordx4 v[116:119], v1, s[48:51], s35 offen offset:1280 nt
    s_waitcnt lgkmcnt(0)
    v_readfirstlane_b32 s75, v243
    s_nop 0
    v_mfma_f32_16x16x32_bf16 v[16:19], v[100:103], v[52:55], v[16:19]
    v_mov_b32_dpp v29, v24 row_newbcast:11 row_mask:0xf bank_mask:0xf
    v_perm_b32 v60, v29, v29, v8
    v_perm_b32 v61, v29, v29, v9
    v_perm_b32 v62, v29, v29, v10
    v_perm_b32 v63, v29, v29, v11
    s_waitcnt vmcnt(2)
    buffer_load_dwordx4 v[120:123], v1, s[48:51], s35 offen offset:1536 nt
    v_mfma_f32_16x16x32_bf16 v[16:19], v[104:107], v[56:59], v[16:19]
    v_mov_b32_dpp v28, v24 row_newbcast:12 row_mask:0xf bank_mask:0xf
    v_perm_b32 v48, v28, v28, v8
    v_perm_b32 v49, v28, v28, v9
    v_perm_b32 v50, v28, v28, v10
    v_perm_b32 v51, v28, v28, v11
    s_waitcnt vmcnt(3)
    s_cmp_ge_u32 s75, 3
    s_cbranch_scc1 L_d117
    s_waitcnt vmcnt(2)
    s_cmp_gt_u32 s75, 1
    s_cbranch_scc1 L_d117
    s_waitcnt vmcnt(1)
L_d117:
    buffer_load_dwordx4 v[124:127], v1, s[48:51], s35 offen offset:1792 nt
    v_mfma_f32_16x16x32_bf16 v[16:19], v[108:111], v[60:63], v[16:19]
    v_mov_b32_dpp v29, v24 row_newbcast:13 row_mask:0xf bank_mask:0xf
    v_perm_b32 v52, v29, v29, v8
    v_perm_b32 v53, v29, v29, v9
    v_perm_b32 v54, v29, v29, v10
    v_perm_b32 v55, v29, v29, v11
    s_waitcnt vmcnt(2)
    s_xor_b32 s52, s33, 262144
    s_add_u32 s53, s52, 0x80000
    buffer_load_dwordx4 v[64:67], v1, s[48:51], s52 offen offset:0 nt
    v_mfma_f32_16x16x32_bf16 v[16:19], v[112:115], v[48:51], v[16:19]
    v_mov_b32_dpp v28, v24 row_newbcast:14 row_mask:0xf bank_mask:0xf
    v_perm_b32 v56, v28, v28, v8
    v_perm_b32 v57, v28, v28, v9
    v_perm_b32 v58, v28, v28, v10
    v_perm_b32 v59, v28, v28, v11
    s_waitcnt vmcnt(3)
    s_cmp_ge_u32 s75, 4
    s_cbranch_scc1 L_d118
    s_waitcnt vmcnt(2)
    s_cmp_gt_u32 s75, 0
    s_cbranch_scc1 L_d118
    s_waitcnt vmcnt(1)
L_d118:
    buffer_load_dwordx4 v[68:71], v1, s[48:51], s52 offen offset:256 nt
    v_mfma_f32_16x16x32_bf16 v[16:19], v[116:119], v[52:55], v[16:19]
    v_mov_b32_dpp v29, v24 row_newbcast:15 row_mask:0xf bank_mask:0xf
    v_perm_b32 v60, v29, v29, v8
    v_perm_b32 v61, v29, v29, v9
    v_perm_b32 v62, v29, v29, v10
    v_perm_b32 v63, v29, v29, v11
    s_waitcnt vmcnt(2)
    buffer_load_dwordx4 v[72:75], v1, s[48:51], s52 offen offset:512 nt
    v_mfma_f32_16x16x32_bf16 v[16:19], v[120:123], v[56:59], v[16:19]
    v_mov_b32_dpp v28, v25 row_newbcast:0 row_mask:0xf bank_mask:0xf
    v_perm_b32 v48, v28, v28, v8
    v_perm_b32 v49, v28, v28, v9
    v_perm_b32 v50, v28, v28, v10
    v_perm_b32 v51, v28, v28, v11
    s_waitcnt vmcnt(3)
    s_cmp_ge_u32 s75, 3
    s_cbranch_scc1 L_d119
    s_waitcnt vmcnt(2)
    s_cmp_gt_u32 s75, 1
    s_cbranch_scc1 L_d119
    s_waitcnt vmcnt(1)
L_d119:
    buffer_load_dwordx4 v[76:79], v1, s[48:51], s52 offen offset:768 nt
    s_cmp_lg_u32 s3, 0
    s_cbranch_scc1 L_a120
    v_readlane_b32 s83, v240, 12
    s_mov_b32 s43, 1
    s_nop 3
    s_and_b32 s83, s83, 0xfff80
    s_atomic_add s43, s[76:77], s83 glc
L_a120:
    v_mfma_f32_16x16x32_bf16 v[16:19], v[124:127], v[60:63], v[16:19]
    v_mov_b32_dpp v29, v25 row_newbcast:1 row_mask:0xf bank_mask:0xf
    v_perm_b32 v52, v29, v29, v8
    v_perm_b32 v53, v29, v29, v9
    v_perm_b32 v54, v29, v29, v10
    v_perm_b32 v55, v29, v29, v11
    s_waitcnt vmcnt(2)
    buffer_load_dwordx4 v[80:83], v1, s[48:51], s52 offen offset:1024 nt
    v_mfma_f32_16x16x32_bf16 v[12:15], v[64:67], v[48:51], v[12:15]
    v_mov_b32_dpp v28, v25 row_newbcast:2 row_mask:0xf bank_mask:0xf
    v_perm_b32 v56, v28, v28, v8
    v_perm_b32 v57, v28, v28, v9
    v_perm_b32 v58, v28, v28, v10
    v_perm_b32 v59, v28, v28, v11
    s_waitcnt vmcnt(3)
    s_cmp_ge_u32 s75, 4
    s_cbranch_scc1 L_d121
    s_waitcnt vmcnt(2)
    s_cmp_gt_u32 s75, 0
    s_cbranch_scc1 L_d121
    s_waitcnt vmcnt(1)
L_d121:
    buffer_load_dwordx4 v[84:87], v1, s[48:51], s52 offen offset:1280 nt
    v_mfma_f32_16x16x32_bf16 v[12:15], v[68:71], v[52:55], v[12:15]
    v_mov_b32_dpp v29, v25 row_newbcast:3 row_mask:0xf bank_mask:0xf
    v_perm_b32 v60, v29, v29, v8
    v_perm_b32 v61, v29, v29, v9
    v_perm_b32 v62, v29, v29, v10
    v_perm_b32 v63, v29, v29, v11
    s_waitcnt vmcnt(2)
    buffer_load_dwordx4 v[88:91], v1, s[48:51], s52 offen offset:1536 nt
    v_mfma_f32_16x16x32_bf16 v[12:15], v[72:75], v[56:59], v[12:15]
    v_mov_b32_dpp v28, v25 row_newbcast:4 row_mask:0xf bank_mask:0xf
    v_perm_b32 v48, v28, v28, v8
    v_perm_b32 v49, v28, v28, v9
    v_perm_b32 v50, v28, v28, v10
    v_perm_b32 v51, v28, v28, v11
    s_waitcnt vmcnt(3)
    s_cmp_ge_u32 s75, 3
    s_cbranch_scc1 L_d122
    s_waitcnt vmcnt(2)
    s_cmp_gt_u32 s75, 1
    s_cbranch_scc1 L_d122
    s_waitcnt vmcnt(1)
L_d122:
    buffer_load_dwordx4 v[92:95], v1, s[48:51], s52 offen offset:1792 nt
    v_mfma_f32_16x16x32_bf16 v[12:15], v[76:79], v[60:63], v[12:15]
    v_mov_b32_dpp v29, v25 row_newbcast:5 row_mask:0xf bank_mask:0xf
    v_perm_b32 v52, v29, v29, v8
    v_perm_b32 v53, v29, v29, v9
    v_perm_b32 v54, v29, v29, v10
    v_perm_b32 v55, v29, v29, v11
    s_waitcnt vmcnt(2)
    buffer_load_dwordx4 v[96:99], v1, s[48:51], s53 offen offset:0 nt
    v_mfma_f32_16x16x32_bf16 v[12:15], v[80:83], v[48:51], v[12:15]
    v_mov_b32_dpp v28, v25 row_newbcast:6 row_mask:0xf bank_mask:0xf
    v_perm_b32 v56, v28, v28, v8
    v_perm_b32 v57, v28, v28, v9
    v_perm_b32 v58, v28, v28, v10
    v_perm_b32 v59, v28, v28, v11
    s_waitcnt vmcnt(3)
    s_cmp_ge_u32 s75, 4
    s_cbranch_scc1 L_d123
    s_waitcnt vmcnt(2)
    s_cmp_gt_u32 s75, 0
    s_cbranch_scc1 L_d123
    s_waitcnt vmcnt(1)
L_d123:
    buffer_load_dwordx4 v[100:103], v1, s[48:51], s53 offen offset:256 nt
    v_readlane_b32 s82, v241, 12
    s_waitcnt lgkmcnt(0)
    s_sub_u32 s43, s43, s82
    s_min_u32 s43, s43, 3
    s_lshl_b32 s43, s43, 2
    s_lshr_b32 s43, 0x3221, s43
    s_and_b32 s43, s43, 7
    v_mov_b32 v243, s43
    s_cmp_lg_u32 s3, 0
    s_cbranch_scc1 L_w124
    ds_write_b32 v244, v243 offset:11264
L_w124:
    v_mfma_f32_16x16x32_bf16 v[12:15], v[84:87], v[52:55], v[12:15]
    v_mov_b32_dpp v29, v25 row_newbcast:7 row_mask:0xf bank_mask:0xf
    v_perm_b32 v60, v29, v29, v8
    v_perm_b32 v61, v29, v29, v9
    v_perm_b32 v62, v29, v29, v10
    v_perm_b32 v63, v29, v29, v11
    s_waitcnt vmcnt(2)
    buffer_load_dwordx4 v[104:107], v1, s[48:51], s53 offen offset:512 nt
    v_mfma_f32_16x16x32_bf16 v[12:15], v[88:91], v[56:59], v[12:15]
    v_mov_b32_dpp v28, v25 row_newbcast:8 row_mask:0xf bank_mask:0xf
    v_perm_b32 v48, v28, v28, v8
    v_perm_b32 v49, v28, v28, v9
    v_perm_b32 v50, v28, v28, v10
    v_perm_b32 v51, v28, v28, v11
    s_waitcnt vmcnt(3)
    s_cmp_ge_u32 s75, 3
    s_cbranch_scc1 L_d125
    s_waitcnt vmcnt(2)
    s_cmp_gt_u32 s75, 1
    s_cbranch_scc1 L_d125
    s_waitcnt vmcnt(1)
L_d125:
    buffer_load_dwordx4 v[108:111], v1, s[48:51], s53 offen offset:768 nt
    v_mfma_f32_16x16x32_bf16 v[12:15], v[92:95], v[60:63], v[12:15]
    v_mov_b32_dpp v29, v25 row_newbcast:9 row_mask:0xf bank_mask:0xf
    v_perm_b32 v52, v29, v29, v8
    v_perm_b32 v53, v29, v29, v9
    v_perm_b32 v54, v29, v29, v10
    v_perm_b32 v55, v29, v29, v11
    s_waitcnt vmcnt(2)
    buffer_load_dwordx4 v[112:115], v1, s[48:51], s53 offen offset:1024 nt
    ds_read_b32 v243, v244 offset:11264
    v_mfma_f32_16x16x32_bf16 v[16:19], v[96:99], v[48:51], v[16:19]
    v_mov_b32_dpp v28, v25 row_newbcast:10 row_mask:0xf bank_mask:0xf
    v_perm_b32 v56, v28, v28, v8
    v_perm_b32 v57, v28, v28, v9
    v_perm_b32 v58, v28, v28, v10
    v_perm_b32 v59, v28, v28, v11
    s_waitcnt vmcnt(3)
    s_cmp_ge_u32 s75, 4
    s_cbranch_scc1 L_d126
    s_waitcnt vmcnt(2)
    s_cmp_gt_u32 s75, 0
    s_cbranch_scc1 L_d126
    s_waitcnt vmcnt(1)
L_d126:
    buffer_load_dwordx4 v[116:119], v1, s[48:51], s53 offen offset:1280 nt
    s_waitcnt lgkmcnt(0)
    v_readfirstlane_b32 s75, v243
    s_nop 0
    v_mfma_f32_16x16x32_bf16 v[16:19], v[100:103], v[52:55], v[16:19]
    v_mov_b32_dpp v29, v25 row_newbcast:11 row_mask:0xf bank_mask:0xf
    v_perm_b32 v60, v29, v29, v8
    v_perm_b32 v61, v29, v29, v9
    v_perm_b32 v62, v29, v29, v10
    v_perm_b32 v63, v29, v29, v11
    s_waitcnt vmcnt(2)
    buffer_load_dwordx4 v[120:123], v1, s[48:51], s53 offen offset:1536 nt
    v_mfma_f32_16x16x32_bf16 v[16:19], v[104:107], v[56:59], v[16:19]
    v_mov_b32_dpp v28, v25 row_newbcast:12 row_mask:0xf bank_mask:0xf
    v_perm_b32 v48, v28, v28, v8
    v_perm_b32 v49, v28, v28, v9
    v_perm_b32 v50, v28, v28, v10
    v_perm_b32 v51, v28, v28, v11
    s_waitcnt vmcnt(3)
    s_cmp_ge_u32 s75, 3
    s_cbranch_scc1 L_d127
    s_waitcnt vmcnt(2)
    s_cmp_gt_u32 s75, 1
    s_cbranch_scc1 L_d127
    s_waitcnt vmcnt(1)
L_d127:
    buffer_load_dwordx4 v[124:127], v1, s[48:51], s53 offen offset:1792 nt
    v_mfma_f32_16x16x32_bf16 v[16:19], v[108:111], v[60:63], v[16:19]
    v_mov_b32_dpp v29, v25 row_newbcast:13 row_mask:0xf bank_mask:0xf
    v_perm_b32 v52, v29, v29, v8
    v_perm_b32 v53, v29, v29, v9
    v_perm_b32 v54, v29, v29, v10
    v_perm_b32 v55, v29, v29, v11
    s_waitcnt vmcnt(2)
    s_xor_b32 s34, s32, 393216
    s_add_u32 s35, s34, 0x80000
    buffer_load_dwordx4 v[64:67], v1, s[48:51], s34 offen offset:0 nt
    v_mfma_f32_16x16x32_bf16 v[16:19], v[112:115], v[48:51], v[16:19]
    v_mov_b32_dpp v28, v25 row_newbcast:14 row_mask:0xf bank_mask:0xf
    v_perm_b32 v56, v28, v28, v8
    v_perm_b32 v57, v28, v28, v9
    v_perm_b32 v58, v28, v28, v10
    v_perm_b32 v59, v28, v28, v11
    s_waitcnt vmcnt(3)
    s_cmp_ge_u32 s75, 4
    s_cbranch_scc1 L_d128
    s_waitcnt vmcnt(2)
    s_cmp_gt_u32 s75, 0
    s_cbranch_scc1 L_d128
    s_waitcnt vmcnt(1)
L_d128:
    buffer_load_dwordx4 v[68:71], v1, s[48:51], s34 offen offset:256 nt
    v_mfma_f32_16x16x32_bf16 v[16:19], v[116:119], v[52:55], v[16:19]
    v_mov_b32_dpp v29, v25 row_newbcast:15 row_mask:0xf bank_mask:0xf
    v_perm_b32 v60, v29, v29, v8
    v_perm_b32 v61, v29, v29, v9
    v_perm_b32 v62, v29, v29, v10
    v_perm_b32 v63, v29, v29, v11
    s_waitcnt vmcnt(2)
    buffer_load_dwordx4 v[72:75], v1, s[48:51], s34 offen offset:512 nt
    v_mfma_f32_16x16x32_bf16 v[16:19], v[120:123], v[56:59], v[16:19]
    v_mov_b32_dpp v28, v26 row_newbcast:0 row_mask:0xf bank_mask:0xf
    v_perm_b32 v48, v28, v28, v8
    v_perm_b32 v49, v28, v28, v9
    v_perm_b32 v50, v28, v28, v10
    v_perm_b32 v51, v28, v28, v11
    s_waitcnt vmcnt(3)
    s_cmp_ge_u32 s75, 3
    s_cbranch_scc1 L_d129
    s_waitcnt vmcnt(2)
    s_cmp_gt_u32 s75, 1
    s_cbranch_scc1 L_d129
    s_waitcnt vmcnt(1)
L_d129:
    buffer_load_dwordx4 v[76:79], v1, s[48:51], s34 offen offset:768 nt
    s_cmp_lg_u32 s3, 0
    s_cbranch_scc1 L_a130
    v_readlane_b32 s83, v240, 13
    s_mov_b32 s43, 1
    s_nop 3
    s_and_b32 s83, s83, 0xfff80
    s_atomic_add s43, s[76:77], s83 glc
L_a130:
    v_mfma_f32_16x16x32_bf16 v[16:19], v[124:127], v[60:63], v[16:19]
    v_mov_b32_dpp v29, v26 row_newbcast:1 row_mask:0xf bank_mask:0xf
    v_perm_b32 v52, v29, v29, v8
    v_perm_b32 v53, v29, v29, v9
    v_perm_b32 v54, v29, v29, v10
    v_perm_b32 v55, v29, v29, v11
    s_waitcnt vmcnt(2)
    buffer_load_dwordx4 v[80:83], v1, s[48:51], s34 offen offset:1024 nt
    v_mfma_f32_16x16x32_bf16 v[12:15], v[64:67], v[48:51], v[12:15]
    v_mov_b32_dpp v28, v26 row_newbcast:2 row_mask:0xf bank_mask:0xf
    v_perm_b32 v56, v28, v28, v8
    v_perm_b32 v57, v28, v28, v9
    v_perm_b32 v58, v28, v28, v10
    v_perm_b32 v59, v28, v28, v11
    s_waitcnt vmcnt(3)
    s_cmp_ge_u32 s75, 4
    s_cbranch_scc1 L_d131
    s_waitcnt vmcnt(2)
    s_cmp_gt_u32 s75, 0
    s_cbranch_scc1 L_d131
    s_waitcnt vmcnt(1)
L_d131:
    buffer_load_dwordx4 v[84:87], v1, s[48:51], s34 offen offset:1280 nt
    v_mfma_f32_16x16x32_bf16 v[12:15], v[68:71], v[52:55], v[12:15]
    v_mov_b32_dpp v29, v26 row_newbcast:3 row_mask:0xf bank_mask:0xf
    v_perm_b32 v60, v29, v29, v8
    v_perm_b32 v61, v29, v29, v9
    v_perm_b32 v62, v29, v29, v10
    v_perm_b32 v63, v29, v29, v11
    s_waitcnt vmcnt(2)
    buffer_load_dwordx4 v[88:91], v1, s[48:51], s34 offen offset:1536 nt
    v_mfma_f32_16x16x32_bf16 v[12:15], v[72:75], v[56:59], v[12:15]
    v_mov_b32_dpp v28, v26 row_newbcast:4 row_mask:0xf bank_mask:0xf
    v_perm_b32 v48, v28, v28, v8
    v_perm_b32 v49, v28, v28, v9
    v_perm_b32 v50, v28, v28, v10
    v_perm_b32 v51, v28, v28, v11
    s_waitcnt vmcnt(3)
    s_cmp_ge_u32 s75, 3
    s_cbranch_scc1 L_d132
    s_waitcnt vmcnt(2)
    s_cmp_gt_u32 s75, 1
    s_cbranch_scc1 L_d132
    s_waitcnt vmcnt(1)
L_d132:
    buffer_load_dwordx4 v[92:95], v1, s[48:51], s34 offen offset:1792 nt
    v_mfma_f32_16x16x32_bf16 v[12:15], v[76:79], v[60:63], v[12:15]
    v_mov_b32_dpp v29, v26 row_newbcast:5 row_mask:0xf bank_mask:0xf
    v_perm_b32 v52, v29, v29, v8
    v_perm_b32 v53, v29, v29, v9
    v_perm_b32 v54, v29, v29, v10
    v_perm_b32 v55, v29, v29, v11
    s_waitcnt vmcnt(2)
    buffer_load_dwordx4 v[96:99], v1, s[48:51], s35 offen offset:0 nt
    v_mfma_f32_16x16x32_bf16 v[12:15], v[80:83], v[48:51], v[12:15]
    v_mov_b32_dpp v28, v26 row_newbcast:6 row_mask:0xf bank_mask:0xf
    v_perm_b32 v56, v28, v28, v8
    v_perm_b32 v57, v28, v28, v9
    v_perm_b32 v58, v28, v28, v10
    v_perm_b32 v59, v28, v28, v11
    s_waitcnt vmcnt(3)
    s_cmp_ge_u32 s75, 4
    s_cbranch_scc1 L_d133
    s_waitcnt vmcnt(2)
    s_cmp_gt_u32 s75, 0
    s_cbranch_scc1 L_d133
    s_waitcnt vmcnt(1)
L_d133:
    buffer_load_dwordx4 v[100:103], v1, s[48:51], s35 offen offset:256 nt
    v_readlane_b32 s82, v241, 13
    s_waitcnt lgkmcnt(0)
    s_sub_u32 s43, s43, s82
    s_min_u32 s43, s43, 3
    s_lshl_b32 s43, s43, 2
    s_lshr_b32 s43, 0x3221, s43
    s_and_b32 s43, s43, 7
    v_mov_b32 v243, s43
    s_cmp_lg_u32 s3, 0
    s_cbranch_scc1 L_w134
    ds_write_b32 v244, v243 offset:11264
L_w134:
    v_mfma_f32_16x16x32_bf16 v[12:15], v[84:87], v[52:55], v[12:15]
    v_mov_b32_dpp v29, v26 row_newbcast:7 row_mask:0xf bank_mask:0xf
    v_perm_b32 v60, v29, v29, v8
    v_perm_b32 v61, v29, v29, v9
    v_perm_b32 v62, v29, v29, v10
    v_perm_b32 v63, v29, v29, v11
    s_waitcnt vmcnt(2)
    buffer_load_dwordx4 v[104:107], v1, s[48:51], s35 offen offset:512 nt
    v_mfma_f32_16x16x32_bf16 v[12:15], v[88:91], v[56:59], v[12:15]
    v_mov_b32_dpp v28, v26 row_newbcast:8 row_mask:0xf bank_mask:0xf
    v_perm_b32 v48, v28, v28, v8
    v_perm_b32 v49, v28, v28, v9
    v_perm_b32 v50, v28, v28, v10
    v_perm_b32 v51, v28, v28, v11
    s_waitcnt vmcnt(3)
    s_cmp_ge_u32 s75, 3
    s_cbranch_scc1 L_d135
    s_waitcnt vmcnt(2)
    s_cmp_gt_u32 s75, 1
    s_cbranch_scc1 L_d135
    s_waitcnt vmcnt(1)
L_d135:
    buffer_load_dwordx4 v[108:111], v1, s[48:51], s35 offen offset:768 nt
    v_mfma_f32_16x16x32_bf16 v[12:15], v[92:95], v[60:63], v[12:15]
    v_mov_b32_dpp v29, v26 row_newbcast:9 row_mask:0xf bank_mask:0xf
    v_perm_b32 v52, v29, v29, v8
    v_perm_b32 v53, v29, v29, v9
    v_perm_b32 v54, v29, v29, v10
    v_perm_b32 v55, v29, v29, v11
    s_waitcnt vmcnt(2)
    buffer_load_dwordx4 v[112:115], v1, s[48:51], s35 offen offset:1024 nt
    ds_read_b32 v243, v244 offset:11264
    v_mfma_f32_16x16x32_bf16 v[16:19], v[96:99], v[48:51], v[16:19]
    v_mov_b32_dpp v28, v26 row_newbcast:10 row_mask:0xf bank_mask:0xf
    v_perm_b32 v56, v28, v28, v8
    v_perm_b32 v57, v28, v28, v9
    v_perm_b32 v58, v28, v28, v10
    v_perm_b32 v59, v28, v28, v11
    s_waitcnt vmcnt(3)
    s_cmp_ge_u32 s75, 4
    s_cbranch_scc1 L_d136
    s_waitcnt vmcnt(2)
    s_cmp_gt_u32 s75, 0
    s_cbranch_scc1 L_d136
    s_waitcnt vmcnt(1)
L_d136:
    buffer_load_dwordx4 v[116:119], v1, s[48:51], s35 offen offset:1280 nt
    s_waitcnt lgkmcnt(0)
    v_readfirstlane_b32 s75, v243
    s_nop 0
    v_mfma_f32_16x16x32_bf16 v[16:19], v[100:103], v[52:55], v[16:19]
    v_mov_b32_dpp v29, v26 row_newbcast:11 row_mask:0xf bank_mask:0xf
    v_perm_b32 v60, v29, v29, v8
    v_perm_b32 v61, v29, v29, v9
    v_perm_b32 v62, v29, v29, v10
    v_perm_b32 v63, v29, v29, v11
    s_waitcnt vmcnt(2)
    buffer_load_dwordx4 v[120:123], v1, s[48:51], s35 offen offset:1536 nt
    v_mfma_f32_16x16x32_bf16 v[16:19], v[104:107], v[56:59], v[16:19]
    v_mov_b32_dpp v28, v26 row_newbcast:12 row_mask:0xf bank_mask:0xf
    v_perm_b32 v48, v28, v28, v8
    v_perm_b32 v49, v28, v28, v9
    v_perm_b32 v50, v28, v28, v10
    v_perm_b32 v51, v28, v28, v11
    s_waitcnt vmcnt(3)
    s_cmp_ge_u32 s75, 3
    s_cbranch_scc1 L_d137
    s_waitcnt vmcnt(2)
    s_cmp_gt_u32 s75, 1
    s_cbranch_scc1 L_d137
    s_waitcnt vmcnt(1)
L_d137:
    buffer_load_dwordx4 v[124:127], v1, s[48:51], s35 offen offset:1792 nt
    v_mfma_f32_16x16x32_bf16 v[16:19], v[108:111], v[60:63], v[16:19]
    v_mov_b32_dpp v29, v26 row_newbcast:13 row_mask:0xf bank_mask:0xf
    v_perm_b32 v52, v29, v29, v8
    v_perm_b32 v53, v29, v29, v9
    v_perm_b32 v54, v29, v29, v10
    v_perm_b32 v55, v29, v29, v11
    s_waitcnt vmcnt(2)
    s_xor_b32 s52, s33, 393216
    s_add_u32 s53, s52, 0x80000
    buffer_load_dwordx4 v[64:67], v1, s[48:51], s52 offen offset:0 nt
    v_mfma_f32_16x16x32_bf16 v[16:19], v[112:115], v[48:51], v[16:19]
    v_mov_b32_dpp v28, v26 row_newbcast:14 row_mask:0xf bank_mask:0xf
    v_perm_b32 v56, v28, v28, v8
    v_perm_b32 v57, v28, v28, v9
    v_perm_b32 v58, v28, v28, v10
    v_perm_b32 v59, v28, v28, v11
    s_waitcnt vmcnt(3)
    s_cmp_ge_u32 s75, 4
    s_cbranch_scc1 L_d138
    s_waitcnt vmcnt(2)
    s_cmp_gt_u32 s75, 0
    s_cbranch_scc1 L_d138
    s_waitcnt vmcnt(1)
L_d138:
    buffer_load_dwordx4 v[68:71], v1, s[48:51], s52 offen offset:256 nt
    v_mfma_f32_16x16x32_bf16 v[16:19], v[116:119], v[52:55], v[16:19]
    v_mov_b32_dpp v29, v26 row_newbcast:15 row_mask:0xf bank_mask:0xf
    v_perm_b32 v60, v29, v29, v8
    v_perm_b32 v61, v29, v29, v9
    v_perm_b32 v62, v29, v29, v10
    v_perm_b32 v63, v29, v29, v11
    s_waitcnt vmcnt(2)
    buffer_load_dwordx4 v[72:75], v1, s[48:51], s52 offen offset:512 nt
    v_mfma_f32_16x16x32_bf16 v[16:19], v[120:123], v[56:59], v[16:19]
    v_mov_b32_dpp v28, v27 row_newbcast:0 row_mask:0xf bank_mask:0xf
    v_perm_b32 v48, v28, v28, v8
    v_perm_b32 v49, v28, v28, v9
    v_perm_b32 v50, v28, v28, v10
    v_perm_b32 v51, v28, v28, v11
    s_waitcnt vmcnt(3)
    s_cmp_ge_u32 s75, 3
    s_cbranch_scc1 L_d139
    s_waitcnt vmcnt(2)
    s_cmp_gt_u32 s75, 1
    s_cbranch_scc1 L_d139
    s_waitcnt vmcnt(1)
L_d139:
    buffer_load_dwordx4 v[76:79], v1, s[48:51], s52 offen offset:768 nt
    s_cmp_lg_u32 s3, 0
    s_cbranch_scc1 L_a140
    v_readlane_b32 s83, v240, 14
    s_mov_b32 s43, 1
    s_nop 3
    s_and_b32 s83, s83, 0xfff80
    s_atomic_add s43, s[76:77], s83 glc
L_a140:
    v_mfma_f32_16x16x32_bf16 v[16:19], v[124:127], v[60:63], v[16:19]
    v_mov_b32_dpp v29, v27 row_newbcast:1 row_mask:0xf bank_mask:0xf
    v_perm_b32 v52, v29, v29, v8
    v_perm_b32 v53, v29, v29, v9
    v_perm_b32 v54, v29, v29, v10
    v_perm_b32 v55, v29, v29, v11
    s_waitcnt vmcnt(2)
    buffer_load_dwordx4 v[80:83], v1, s[48:51], s52 offen offset:1024 nt
    v_mfma_f32_16x16x32_bf16 v[12:15], v[64:67], v[48:51], v[12:15]
    v_mov_b32_dpp v28, v27 row_newbcast:2 row_mask:0xf bank_mask:0xf
    v_perm_b32 v56, v28, v28, v8
    v_perm_b32 v57, v28, v28, v9
    v_perm_b32 v58, v28, v28, v10
    v_perm_b32 v59, v28, v28, v11
    s_waitcnt vmcnt(3)
    s_cmp_ge_u32 s75, 4
    s_cbranch_scc1 L_d141
    s_waitcnt vmcnt(2)
    s_cmp_gt_u32 s75, 0
    s_cbranch_scc1 L_d141
    s_waitcnt vmcnt(1)
L_d141:
    buffer_load_dwordx4 v[84:87], v1, s[48:51], s52 offen offset:1280 nt
    v_mfma_f32_16x16x32_bf16 v[12:15], v[68:71], v[52:55], v[12:15]
    v_mov_b32_dpp v29, v27 row_newbcast:3 row_mask:0xf bank_mask:0xf
    v_perm_b32 v60, v29, v29, v8
    v_perm_b32 v61, v29, v29, v9
    v_perm_b32 v62, v29, v29, v10
    v_perm_b32 v63, v29, v29, v11
    s_waitcnt vmcnt(2)
    buffer_load_dwordx4 v[88:91], v1, s[48:51], s52 offen offset:1536 nt
    v_mfma_f32_16x16x32_bf16 v[12:15], v[72:75], v[56:59], v[12:15]
    v_mov_b32_dpp v28, v27 row_newbcast:4 row_mask:0xf bank_mask:0xf
    v_perm_b32 v48, v28, v28, v8
    v_perm_b32 v49, v28, v28, v9
    v_perm_b32 v50, v28, v28, v10
    v_perm_b32 v51, v28, v28, v11
    s_waitcnt vmcnt(3)
    s_cmp_ge_u32 s75, 3
    s_cbranch_scc1 L_d142
    s_waitcnt vmcnt(2)
    s_cmp_gt_u32 s75, 1
    s_cbranch_scc1 L_d142
    s_waitcnt vmcnt(1)
L_d142:
    buffer_load_dwordx4 v[92:95], v1, s[48:51], s52 offen offset:1792 nt
    v_mfma_f32_16x16x32_bf16 v[12:15], v[76:79], v[60:63], v[12:15]
    v_mov_b32_dpp v29, v27 row_newbcast:5 row_mask:0xf bank_mask:0xf
    v_perm_b32 v52, v29, v29, v8
    v_perm_b32 v53, v29, v29, v9
    v_perm_b32 v54, v29, v29, v10
    v_perm_b32 v55, v29, v29, v11
    s_waitcnt vmcnt(2)
    buffer_load_dwordx4 v[96:99], v1, s[48:51], s53 offen offset:0 nt
    v_mfma_f32_16x16x32_bf16 v[12:15], v[80:83], v[48:51], v[12:15]
    v_mov_b32_dpp v28, v27 row_newbcast:6 row_mask:0xf bank_mask:0xf
    v_perm_b32 v56, v28, v28, v8
    v_perm_b32 v57, v28, v28, v9
    v_perm_b32 v58, v28, v28, v10
    v_perm_b32 v59, v28, v28, v11
    s_waitcnt vmcnt(3)
    s_cmp_ge_u32 s75, 4
    s_cbranch_scc1 L_d143
    s_waitcnt vmcnt(2)
    s_cmp_gt_u32 s75, 0
    s_cbranch_scc1 L_d143
    s_waitcnt vmcnt(1)
L_d143:
    buffer_load_dwordx4 v[100:103], v1, s[48:51], s53 offen offset:256 nt
    v_readlane_b32 s82, v241, 14
    s_waitcnt lgkmcnt(0)
    s_sub_u32 s43, s43, s82
    s_min_u32 s43, s43, 3
    s_lshl_b32 s43, s43, 2
    s_lshr_b32 s43, 0x3221, s43
    s_and_b32 s43, s43, 7
    v_mov_b32 v243, s43
    s_cmp_lg_u32 s3, 0
    s_cbranch_scc1 L_w144
    ds_write_b32 v244, v243 offset:11264
L_w144:
    v_mfma_f32_16x16x32_bf16 v[12:15], v[84:87], v[52:55], v[12:15]
    v_mov_b32_dpp v29, v27 row_newbcast:7 row_mask:0xf bank_mask:0xf
    v_perm_b32 v60, v29, v29, v8
    v_perm_b32 v61, v29, v29, v9
    v_perm_b32 v62, v29, v29, v10
    v_perm_b32 v63, v29, v29, v11
    s_waitcnt vmcnt(2)
    buffer_load_dwordx4 v[104:107], v1, s[48:51], s53 offen offset:512 nt
    v_mfma_f32_16x16x32_bf16 v[12:15], v[88:91], v[56:59], v[12:15]
    v_mov_b32_dpp v28, v27 row_newbcast:8 row_mask:0xf bank_mask:0xf
    v_perm_b32 v48, v28, v28, v8
    v_perm_b32 v49, v28, v28, v9
    v_perm_b32 v50, v28, v28, v10
    v_perm_b32 v51, v28, v28, v11
    s_waitcnt vmcnt(3)
    s_cmp_ge_u32 s75, 3
    s_cbranch_scc1 L_d145
    s_waitcnt vmcnt(2)
    s_cmp_gt_u32 s75, 1
    s_cbranch_scc1 L_d145
    s_waitcnt vmcnt(1)
L_d145:
    buffer_load_dwordx4 v[108:111], v1, s[48:51], s53 offen offset:768 nt
    v_mfma_f32_16x16x32_bf16 v[12:15], v[92:95], v[60:63], v[12:15]
    v_mov_b32_dpp v29, v27 row_newbcast:9 row_mask:0xf bank_mask:0xf
    v_perm_b32 v52, v29, v29, v8
    v_perm_b32 v53, v29, v29, v9
    v_perm_b32 v54, v29, v29, v10
    v_perm_b32 v55, v29, v29, v11
    s_waitcnt vmcnt(2)
    buffer_load_dwordx4 v[112:115], v1, s[48:51], s53 offen offset:1024 nt
    ds_read_b32 v243, v244 offset:11264
    v_mfma_f32_16x16x32_bf16 v[16:19], v[96:99], v[48:51], v[16:19]
    v_mov_b32_dpp v28, v27 row_newbcast:10 row_mask:0xf bank_mask:0xf
    v_perm_b32 v56, v28, v28, v8
    v_perm_b32 v57, v28, v28, v9
    v_perm_b32 v58, v28, v28, v10
    v_perm_b32 v59, v28, v28, v11
    s_waitcnt vmcnt(3)
    s_cmp_ge_u32 s75, 4
    s_cbranch_scc1 L_d146
    s_waitcnt vmcnt(2)
    s_cmp_gt_u32 s75, 0
    s_cbranch_scc1 L_d146
    s_waitcnt vmcnt(1)
L_d146:
    buffer_load_dwordx4 v[116:119], v1, s[48:51], s53 offen offset:1280 nt
    s_waitcnt lgkmcnt(0)
    v_readfirstlane_b32 s75, v243
    s_nop 0
    v_mfma_f32_16x16x32_bf16 v[16:19], v[100:103], v[52:55], v[16:19]
    v_mov_b32_dpp v29, v27 row_newbcast:11 row_mask:0xf bank_mask:0xf
    v_perm_b32 v60, v29, v29, v8
    v_perm_b32 v61, v29, v29, v9
    v_perm_b32 v62, v29, v29, v10
    v_perm_b32 v63, v29, v29, v11
    s_waitcnt vmcnt(2)
    buffer_load_dwordx4 v[120:123], v1, s[48:51], s53 offen offset:1536 nt
    v_mfma_f32_16x16x32_bf16 v[16:19], v[104:107], v[56:59], v[16:19]
    v_mov_b32_dpp v28, v27 row_newbcast:12 row_mask:0xf bank_mask:0xf
    v_perm_b32 v48, v28, v28, v8
    v_perm_b32 v49, v28, v28, v9
    v_perm_b32 v50, v28, v28, v10
    v_perm_b32 v51, v28, v28, v11
    s_waitcnt vmcnt(3)
    s_cmp_ge_u32 s75, 3
    s_cbranch_scc1 L_d147
    s_waitcnt vmcnt(2)
    s_cmp_gt_u32 s75, 1
    s_cbranch_scc1 L_d147
    s_waitcnt vmcnt(1)
L_d147:
    buffer_load_dwordx4 v[124:127], v1, s[48:51], s53 offen offset:1792 nt
    v_mfma_f32_16x16x32_bf16 v[16:19], v[108:111], v[60:63], v[16:19]
    v_mov_b32_dpp v29, v27 row_newbcast:13 row_mask:0xf bank_mask:0xf
    v_perm_b32 v52, v29, v29, v8
    v_perm_b32 v53, v29, v29, v9
    v_perm_b32 v54, v29, v29, v10
    v_perm_b32 v55, v29, v29, v11
    s_waitcnt vmcnt(3)
    v_mfma_f32_16x16x32_bf16 v[16:19], v[112:115], v[48:51], v[16:19]
    v_mov_b32_dpp v28, v27 row_newbcast:14 row_mask:0xf bank_mask:0xf
    v_perm_b32 v56, v28, v28, v8
    v_perm_b32 v57, v28, v28, v9
    v_perm_b32 v58, v28, v28, v10
    v_perm_b32 v59, v28, v28, v11
    s_waitcnt vmcnt(2)
    v_mfma_f32_16x16x32_bf16 v[16:19], v[116:119], v[52:55], v[16:19]
    v_mov_b32_dpp v29, v27 row_newbcast:15 row_mask:0xf bank_mask:0xf
    v_perm_b32 v60, v29, v29, v8
    v_perm_b32 v61, v29, v29, v9
    v_perm_b32 v62, v29, v29, v10
    v_perm_b32 v63, v29, v29, v11
    s_waitcnt vmcnt(1)
    v_mfma_f32_16x16x32_bf16 v[16:19], v[120:123], v[56:59], v[16:19]
    s_waitcnt vmcnt(0)
    v_mfma_f32_16x16x32_bf16 v[16:19], v[124:127], v[60:63], v[16:19]
    v_and_b32 v6, 7, v0
    v_lshlrev_b32 v6, 2, v6
    v_lshl_add_u32 v6, v5, 9, v6
    v_lshrrev_b32 v7, 4, v0
    v_lshl_add_u32 v6, v7, 7, v6
    s_lshl_b32 s38, s3, 10
    v_add_u32 v6, s38, v6
    v_add_f32_dpp v32, v12, v12 row_ror:8 row_mask:0xf bank_mask:0x3
    v_add_f32_dpp v32, v16, v16 row_ror:8 row_mask:0xf bank_mask:0xc
    v_add_f32_dpp v33, v13, v13 row_ror:8 row_mask:0xf bank_mask:0x3
    v_add_f32_dpp v33, v17, v17 row_ror:8 row_mask:0xf bank_mask:0xc
    v_add_f32_dpp v34, v14, v14 row_ror:8 row_mask:0xf bank_mask:0x3
    v_add_f32_dpp v34, v18, v18 row_ror:8 row_mask:0xf bank_mask:0xc
    v_add_f32_dpp v35, v15, v15 row_ror:8 row_mask:0xf bank_mask:0x3
    v_add_f32_dpp v35, v19, v19 row_ror:8 row_mask:0xf bank_mask:0xc
    ds_write_b32 v6, v32 offset:12288
    ds_write_b32 v6, v33 offset:12320
    ds_write_b32 v6, v34 offset:12352
    ds_write_b32 v6, v35 offset:12384
    v_lshlrev_b32 v6, 4, v0
    v_and_b32 v7, 31, v0
    v_lshlrev_b32 v7, 3, v7
    v_lshrrev_b32 v28, 5, v0
    v_mul_lo_u32 v28, s74, v28
    v_add_u32 v7, v7, v28
    s_mov_b32 s28, s14
    s_mov_b32 s29, s15
    s_waitcnt lgkmcnt(0)
    s_barrier
    s_cmp_lg_u32 s3, 0
    s_cbranch_scc1 L_end
    ds_read_b128 v[32:35], v6 offset:12288
    ds_read_b128 v[36:39], v6 offset:13312
    ds_read_b128 v[40:43], v6 offset:14336
    ds_read_b128 v[44:47], v6 offset:15360
    ds_read_b128 v[48:51], v6 offset:16384
    ds_read_b128 v[52:55], v6 offset:17408
    ds_read_b128 v[56:59], v6 offset:18432
    ds_read_b128 v[60:63], v6 offset:19456
    s_waitcnt lgkmcnt(0)
    v_pk_add_f32 v[32:33], v[32:33], v[36:37]
    v_pk_add_f32 v[34:35], v[34:35], v[38:39]
    v_pk_add_f32 v[40:41], v[40:41], v[44:45]
    v_pk_add_f32 v[42:43], v[42:43], v[46:47]
    v_pk_add_f32 v[48:49], v[48:49], v[52:53]
    v_pk_add_f32 v[50:51], v[50:51], v[54:55]
    v_pk_add_f32 v[56:57], v[56:57], v[60:61]
    v_pk_add_f32 v[58:59], v[58:59], v[62:63]
    v_pk_add_f32 v[32:33], v[32:33], v[40:41]
    v_pk_add_f32 v[34:35], v[34:35], v[42:43]
    v_pk_add_f32 v[48:49], v[48:49], v[56:57]
    v_pk_add_f32 v[50:51], v[50:51], v[58:59]
    v_pk_add_f32 v[32:33], v[32:33], v[48:49]
    v_pk_add_f32 v[34:35], v[34:35], v[50:51]
    v_cvt_pk_bf16_f32 v20, v32, v33
    v_cvt_pk_bf16_f32 v21, v34, v35
    buffer_store_dwordx2 v[20:21], v7, s[28:31], s47 offen
L_end:
    s_endpgm
.section .rodata,"a"
.p2align 6
.amdhsa_kernel standalone__low_rank_proj_linformer__sampling_kernel
  .amdhsa_next_free_vgpr 256
  .amdhsa_next_free_sgpr 88
  .amdhsa_accum_offset 256
  .amdhsa_group_segment_fixed_size 0
  .amdhsa_kernarg_size 64
  .amdhsa_user_sgpr_count 2
  .amdhsa_user_sgpr_kernarg_segment_ptr 1
  .amdhsa_system_sgpr_workgroup_id_x 1
.end_amdhsa_kernel
```
